```python
import torch

def _softmax(x, axis=-1):
    return torch.softmax(x, dim=axis)
def _gelu(x):
    return torch.nn.functional.gelu(x, approximate="tanh")
def _silu(x):
    return torch.nn.functional.silu(x)
def _sigmoid(x):
    return torch.sigmoid(x)
def _layernorm(x, axis=-1, eps=1e-5):
    m = x.mean(dim=axis, keepdim=True)
    v = x.var(dim=axis, keepdim=True, unbiased=False)
    return (x - m) / torch.sqrt(v + eps)
def _scatter_add(tgt, idx, src, axis=0):
    return tgt.clone().index_add_(axis, idx, src)
def _segment_sum(src, seg, n):
    out = torch.zeros((n,) + src.shape[1:], dtype=src.dtype)
    return out.index_add_(0, seg, src)
def _pad(x, pw):
    flat = tuple(v for pair in reversed(pw) for v in pair)
    return torch.nn.functional.pad(x, flat)

kernel_name = 'parallel_sum__compressed_kv_cla__dense_activation_squared_relu__decode'

def setup_inputs():

    _w = (lambda a: (lambda t: t.to(torch.bfloat16) if t.is_floating_point() else t)(torch.as_tensor(a)))
    def _A_setup():
        B, H, Sq, Sk, D, M = 1, 32, 1, 16384, 128, 512
        Dc = 4 * D
        return {
            "x": _w((lambda *s: torch.randn(*s, dtype=torch.bfloat16) * 0.05)(B, Sq, M)),
            "c_kv": _w((lambda *s: torch.randn(*s, dtype=torch.bfloat16) * 3.2)(B, Sk, Dc)),
            "w_q": _w((lambda *s: torch.randn(*s, dtype=torch.bfloat16) * 1.6)(M, H, D) * (M ** -0.5)),
            "w_uk": _w((lambda *s: torch.randn(*s, dtype=torch.bfloat16) * 1.6)(Dc, H, D) * (Dc ** -0.5)),
            "w_uv": _w((lambda *s: torch.randn(*s, dtype=torch.bfloat16) * 3.2)(Dc, H, D) * (Dc ** -0.5)),
            "w_o": _w((lambda *s: torch.randn(*s, dtype=torch.bfloat16) * 3.2)(H, D, M) * ((H * D) ** -0.5)),
        }
    _A_in = _A_setup()

    def _B_setup():
        B, S, D, F = 1, 1, 512, 1792
        return {
            "x": _w((lambda *s: torch.randn(*s, dtype=torch.bfloat16) * 0.05)(B, S, D)),
            "w1": _w((lambda *s: torch.randn(*s, dtype=torch.bfloat16) * 0.1)(D, F)),
            "b1": _w((lambda *s: torch.randn(*s, dtype=torch.bfloat16) * 0.8)(F)),
            "w2": _w((lambda *s: torch.randn(*s, dtype=torch.bfloat16) * 0.1)(F, D)),
            "b2": _w((lambda *s: torch.randn(*s, dtype=torch.bfloat16) * 12.8)(D)),
        }
    _B_in = _B_setup()

    return {
        "A_x": _A_in["x"],
        "A_c_kv": _A_in["c_kv"],
        "A_w_q": _A_in["w_q"],
        "A_w_uk": _A_in["w_uk"],
        "A_w_uv": _A_in["w_uv"],
        "A_w_o": _A_in["w_o"],
        "B_x": _B_in["x"],
        "B_w1": _B_in["w1"],
        "B_b1": _B_in["b1"],
        "B_w2": _B_in["w2"],
        "B_b2": _B_in["b2"],
    }

def reference(A_x, A_c_kv, A_w_q, A_w_uk, A_w_uv, A_w_o, B_x, B_w1, B_b1, B_w2, B_b2):
    def _A_ref(x, c_kv, w_q, w_uk, w_uv, w_o):
        B, Sq, M = x.shape[0], x.shape[1], x.shape[2]
        Sk = c_kv.shape[1]
        H, D = w_q.shape[1], w_q.shape[2]
        q = torch.einsum("bqm,mhd->bhqd", x, w_q)
        k = torch.einsum("bkc,chd->bhkd", c_kv, w_uk)
        v = torch.einsum("bkc,chd->bhkd", c_kv, w_uv)
        scores = torch.einsum("bhqd,bhkd->bhqk", q, k) * (D ** -0.5)
        off = Sk - Sq
        qi = torch.arange(Sq)[:, None]
        kj = torch.arange(Sk)[None, :]
        cmask = kj <= (qi + off)
        scores = torch.where(cmask[None, None], scores, -1e9)
        p = _softmax(scores, axis=-1)
        ctx = torch.einsum("bhqk,bhkd->bhqd", p, v)
        return torch.einsum("bhqd,hdm->bqm", ctx, w_o)

    def _B_ref(x, w1, b1, w2, b2):
        h = torch.einsum("bsd,df->bsf", x, w1) + b1
        zero = torch.zeros_like(h)
        r = torch.where(h > zero, h, zero)
        h = r * r
        out = torch.einsum("bsf,fd->bsd", h, w2) + b2
        return out

    x = A_x
    xn = _layernorm(x, axis=-1)
    return x + _A_ref(xn, A_c_kv, A_w_q, A_w_uk, A_w_uv, A_w_o) + _B_ref(xn, B_w1, B_b1, B_w2, B_b2)
```

```asm
; @launch grid=(256,1,1) block=(512,1,1) lds=163840
.amdgcn_target "amdgcn-amd-amdhsa--gfx950"
.text
.globl parallel_sum__compressed_kv_cla__dense_activation_squared_relu__decode_kernel
.p2align 8
.type parallel_sum__compressed_kv_cla__dense_activation_squared_relu__decode_kernel,@function
parallel_sum__compressed_kv_cla__dense_activation_squared_relu__decode_kernel:
    s_load_dwordx4 s[48:51], s[0:1], 16
    s_load_dwordx4 s[40:43], s[0:1], 0
    s_load_dwordx2 s[56:57], s[0:1], 104
    v_lshrrev_b32 v1, 6, v0
    s_cmp_ge_u32 s2, 16
    s_cbranch_scc1 L_nopf
    s_getpc_b64 s[10:11]
L_pc:
    v_lshlrev_b32 v4, 6, v0
    v_min_u32 v4, L_codeend - L_pc - 4, v4
    global_load_dword v255, v4, s[10:11]
L_nopf:
    v_readfirstlane_b32 s3, v1
    s_lshr_b32 s5, s2, 4
    s_cmp_ge_u32 s5, 16
    s_cbranch_scc1 L_end
    v_and_b32 v0, 63, v0
    s_and_b32 s4, s2, 7
    s_bitcmp1_b32 s2, 3
    s_cbranch_scc0 L_WGT
    s_cmp_ge_u32 s3, 4
    s_cbranch_scc1 L_ATT_stub
    v_lshrrev_b32 v4, 1, v0
    v_and_b32 v5, 1, v0
    v_lshlrev_b32 v4, 11, v4
    v_lshl_add_u32 v4, v5, 7, v4
    v_bfe_u32 v5, v0, 1, 2
    v_mad_u32_u24 v5, v5, 1, s4
    v_and_b32 v5, 7, v5
    v_lshl_add_u32 v4, v5, 8, v4
    s_lshl2_add_u32 s16, s5, s3
    v_lshl_add_u32 v126, s16, 16, v4
    s_waitcnt lgkmcnt(0)
    global_load_dword v121, v126, s[48:49]
    s_branch L_ATT
L_WGT:
    s_cmp_eq_u32 s3, 7
    s_cbranch_scc1 L_warm
L_WGT1:
    s_lshl_b32 s8, s5, 2
    v_add_u32 v5, s8, v0
    v_lshlrev_b32 v4, 4, v0
    v_bfi_b32 v5, 15, v5, v0
    s_lshl_b32 s11, s3, 7
    v_lshl_add_u32 v5, v5, 1, s11
    s_waitcnt lgkmcnt(0)
    global_load_dwordx4 v[8:11], v4, s[40:41]
    global_load_ushort v12, v5, s[40:41]
    s_lshr_b32 s7, s5, 2
    s_mul_i32 s8, s7, 1
    s_add_u32 s8, s8, s4
    s_and_b32 s8, s8, 7
    s_lshl3_add_u32 s7, s7, s8
    s_and_b32 s8, s5, 3
    s_lshl_b32 s17, s7, 8
    v_and_b32 v2, 15, v0
    v_lshrrev_b32 v3, 4, v0
    s_lshl_b32 s10, s3, 19
    s_lshl_b32 s11, s8, 15
    s_add_u32 s10, s10, s11
    s_add_u32 s10, s10, s17
    v_lshlrev_b32 v6, 17, v3
    v_lshl_add_u32 v6, v2, 4, v6
    s_movk_i32 s12, 0x2000
    s_mov_b64 s[52:53], s[50:51]
    s_mov_b64 s[44:45], s[42:43]
    s_mov_b32 s50, 4194304
    s_mov_b32 s51, 0x20000
    s_branch L_WGT2
L_warm:
    s_branch L_WGT1
L_WGT2:
    s_barrier
    buffer_load_dwordx4 v[64:67], v6, s[48:51], s10 offen
    s_add_u32 s10, s10, s12
    buffer_load_dwordx4 v[68:71], v6, s[48:51], s10 offen
    s_add_u32 s10, s10, s12
    buffer_load_dwordx4 v[72:75], v6, s[48:51], s10 offen
    s_add_u32 s10, s10, s12
    buffer_load_dwordx4 v[76:79], v6, s[48:51], s10 offen
    s_cmp_eq_u32 s8, 3
    s_cselect_b32 s13, 4294844416, s12
    s_add_u32 s10, s10, s13
    s_load_dword s35, s[56:57], 0
    s_mov_b32 s28, 0
    s_mov_b32 s58, 16777216
    s_mov_b32 s59, 0x20000
    v_lshlrev_b32 v41, 5, v2
    v_lshl_add_u32 v41, v3, 4, v41
    v_and_b32 v36, 1, v0
    v_lshlrev_b32 v36, 4, v36
    v_mov_b32 v37, 0xffff
    v_lshlrev_b32 v36, v36, v37
    v_bfe_u32 v37, v0, 1, 3
    v_cmp_eq_u32 vcc, 0, v37
    s_nop 1
    v_cndmask_b32 v32, 0, v36, vcc
    v_cmp_eq_u32 vcc, 1, v37
    s_nop 1
    v_cndmask_b32 v33, 0, v36, vcc
    v_cmp_eq_u32 vcc, 2, v37
    s_nop 1
    v_cndmask_b32 v34, 0, v36, vcc
    v_cmp_eq_u32 vcc, 3, v37
    s_nop 1
    v_cndmask_b32 v35, 0, v36, vcc
    buffer_load_dwordx4 v[80:83], v6, s[48:51], s10 offen
    s_add_u32 s10, s10, s12
    buffer_load_dwordx4 v[84:87], v6, s[48:51], s10 offen
    s_add_u32 s10, s10, s12
    buffer_load_dwordx4 v[88:91], v6, s[48:51], s10 offen
    s_add_u32 s10, s10, s12
    buffer_load_dwordx4 v[92:95], v6, s[48:51], s10 offen
    s_cmp_eq_u32 s8, 2
    s_cselect_b32 s13, 4294844416, s12
    s_add_u32 s10, s10, s13
    s_waitcnt vmcnt(8)
    v_lshlrev_b32 v16, 16, v8
    v_and_b32 v17, 0xffff0000, v8
    v_lshlrev_b32 v18, 16, v9
    v_and_b32 v19, 0xffff0000, v9
    v_lshlrev_b32 v20, 16, v10
    v_and_b32 v21, 0xffff0000, v10
    v_lshlrev_b32 v22, 16, v11
    v_and_b32 v23, 0xffff0000, v11
    v_add_f32 v24, v16, v17
    v_add_f32 v25, v18, v19
    v_add_f32 v26, v20, v21
    v_add_f32 v27, v22, v23
    v_add_f32 v24, v24, v25
    v_add_f32 v26, v26, v27
    v_add_f32 v24, v24, v26
    s_nop 1
    v_add_f32_dpp v24, v24, v24 row_ror:1 row_mask:0xf bank_mask:0xf
    s_nop 1
    v_add_f32_dpp v24, v24, v24 row_ror:2 row_mask:0xf bank_mask:0xf
    s_nop 1
    v_add_f32_dpp v24, v24, v24 row_ror:4 row_mask:0xf bank_mask:0xf
    s_nop 1
    v_add_f32_dpp v24, v24, v24 row_ror:8 row_mask:0xf bank_mask:0xf
    v_mov_b32 v26, v24
    s_nop 1
    v_permlane16_swap_b32 v26, v24
    v_add_f32 v24, v24, v26
    v_mov_b32 v26, v24
    s_nop 1
    v_permlane32_swap_b32 v26, v24
    v_add_f32 v24, v24, v26
    v_mul_f32 v24, 989855744, v24
    v_sub_f32 v26, v16, v24
    v_mul_f32 v25, v26, v26
    v_sub_f32 v27, v17, v24
    v_fmac_f32 v25, v27, v27
    v_sub_f32 v26, v18, v24
    v_fmac_f32 v25, v26, v26
    v_sub_f32 v27, v19, v24
    v_fmac_f32 v25, v27, v27
    v_sub_f32 v26, v20, v24
    v_fmac_f32 v25, v26, v26
    v_sub_f32 v27, v21, v24
    v_fmac_f32 v25, v27, v27
    v_sub_f32 v26, v22, v24
    v_fmac_f32 v25, v26, v26
    v_sub_f32 v27, v23, v24
    v_fmac_f32 v25, v27, v27
    s_nop 1
    v_add_f32_dpp v25, v25, v25 row_ror:1 row_mask:0xf bank_mask:0xf
    s_nop 1
    v_add_f32_dpp v25, v25, v25 row_ror:2 row_mask:0xf bank_mask:0xf
    s_nop 1
    v_add_f32_dpp v25, v25, v25 row_ror:4 row_mask:0xf bank_mask:0xf
    s_nop 1
    v_add_f32_dpp v25, v25, v25 row_ror:8 row_mask:0xf bank_mask:0xf
    v_mov_b32 v26, v25
    s_nop 1
    v_permlane16_swap_b32 v26, v25
    v_add_f32 v25, v25, v26
    v_mov_b32 v26, v25
    s_nop 1
    v_permlane32_swap_b32 v26, v25
    v_add_f32 v25, v25, v26
    v_mul_f32 v25, 989855744, v25
    v_cvt_pk_bf16_f32 v24, v24, v24
    v_and_b32 v24, 0xffff0000, v24
    v_cvt_pk_bf16_f32 v25, v25, v25
    v_and_b32 v25, 0xffff0000, v25
    v_add_f32 v25, 925353388, v25
    v_cvt_pk_bf16_f32 v25, v25, v25
    v_and_b32 v25, 0xffff0000, v25
    v_sqrt_f32 v25, v25
    s_nop 0
    v_cvt_pk_bf16_f32 v25, v25, v25
    v_and_b32 v25, 0xffff0000, v25
    v_rcp_f32 v25, v25
    v_lshlrev_b32 v12, 16, v12
    v_sub_f32 v12, v12, v24
    v_cvt_pk_bf16_f32 v12, v12, v12
    v_and_b32 v12, 0xffff0000, v12
    v_mul_f32 v12, v12, v25
    v_cvt_pk_bf16_f32 v12, v12, v12
    s_cmp_lg_u32 s3, 3
    s_cbranch_scc1 L_noxn
    v_sub_f32 v16, v16, v24
    v_sub_f32 v17, v17, v24
    v_sub_f32 v18, v18, v24
    v_sub_f32 v19, v19, v24
    v_sub_f32 v20, v20, v24
    v_sub_f32 v21, v21, v24
    v_sub_f32 v22, v22, v24
    v_sub_f32 v23, v23, v24
    v_cvt_pk_bf16_f32 v56, v16, v17
    v_cvt_pk_bf16_f32 v57, v18, v19
    v_cvt_pk_bf16_f32 v58, v20, v21
    v_cvt_pk_bf16_f32 v59, v22, v23
    v_lshlrev_b32 v16, 16, v56
    v_and_b32 v17, 0xffff0000, v56
    v_lshlrev_b32 v18, 16, v57
    v_and_b32 v19, 0xffff0000, v57
    v_lshlrev_b32 v20, 16, v58
    v_and_b32 v21, 0xffff0000, v58
    v_lshlrev_b32 v22, 16, v59
    v_and_b32 v23, 0xffff0000, v59
    v_mul_f32 v16, v16, v25
    v_mul_f32 v17, v17, v25
    v_mul_f32 v18, v18, v25
    v_mul_f32 v19, v19, v25
    v_mul_f32 v20, v20, v25
    v_mul_f32 v21, v21, v25
    v_mul_f32 v22, v22, v25
    v_mul_f32 v23, v23, v25
    v_cvt_pk_bf16_f32 v56, v16, v17
    v_cvt_pk_bf16_f32 v57, v18, v19
    v_cvt_pk_bf16_f32 v58, v20, v21
    v_cvt_pk_bf16_f32 v59, v22, v23
L_noxn:
    v_and_b32_dpp v128, v12, v32 row_newbcast:0 row_mask:0xf bank_mask:0xf
    v_and_b32_dpp v129, v12, v33 row_newbcast:0 row_mask:0xf bank_mask:0xf
    v_and_b32_dpp v130, v12, v34 row_newbcast:0 row_mask:0xf bank_mask:0xf
    v_and_b32_dpp v131, v12, v35 row_newbcast:0 row_mask:0xf bank_mask:0xf
    v_and_b32_dpp v132, v12, v32 row_newbcast:1 row_mask:0xf bank_mask:0xf
    v_and_b32_dpp v133, v12, v33 row_newbcast:1 row_mask:0xf bank_mask:0xf
    v_and_b32_dpp v134, v12, v34 row_newbcast:1 row_mask:0xf bank_mask:0xf
    v_and_b32_dpp v135, v12, v35 row_newbcast:1 row_mask:0xf bank_mask:0xf
    v_and_b32_dpp v136, v12, v32 row_newbcast:2 row_mask:0xf bank_mask:0xf
    v_and_b32_dpp v137, v12, v33 row_newbcast:2 row_mask:0xf bank_mask:0xf
    v_and_b32_dpp v138, v12, v34 row_newbcast:2 row_mask:0xf bank_mask:0xf
    v_and_b32_dpp v139, v12, v35 row_newbcast:2 row_mask:0xf bank_mask:0xf
    v_and_b32_dpp v140, v12, v32 row_newbcast:3 row_mask:0xf bank_mask:0xf
    v_and_b32_dpp v141, v12, v33 row_newbcast:3 row_mask:0xf bank_mask:0xf
    v_and_b32_dpp v142, v12, v34 row_newbcast:3 row_mask:0xf bank_mask:0xf
    v_and_b32_dpp v143, v12, v35 row_newbcast:3 row_mask:0xf bank_mask:0xf
    v_and_b32_dpp v144, v12, v32 row_newbcast:4 row_mask:0xf bank_mask:0xf
    v_and_b32_dpp v145, v12, v33 row_newbcast:4 row_mask:0xf bank_mask:0xf
    v_and_b32_dpp v146, v12, v34 row_newbcast:4 row_mask:0xf bank_mask:0xf
    v_and_b32_dpp v147, v12, v35 row_newbcast:4 row_mask:0xf bank_mask:0xf
    v_and_b32_dpp v148, v12, v32 row_newbcast:5 row_mask:0xf bank_mask:0xf
    v_and_b32_dpp v149, v12, v33 row_newbcast:5 row_mask:0xf bank_mask:0xf
    v_and_b32_dpp v150, v12, v34 row_newbcast:5 row_mask:0xf bank_mask:0xf
    v_and_b32_dpp v151, v12, v35 row_newbcast:5 row_mask:0xf bank_mask:0xf
    v_and_b32_dpp v152, v12, v32 row_newbcast:6 row_mask:0xf bank_mask:0xf
    v_and_b32_dpp v153, v12, v33 row_newbcast:6 row_mask:0xf bank_mask:0xf
    v_and_b32_dpp v154, v12, v34 row_newbcast:6 row_mask:0xf bank_mask:0xf
    v_and_b32_dpp v155, v12, v35 row_newbcast:6 row_mask:0xf bank_mask:0xf
    v_and_b32_dpp v156, v12, v32 row_newbcast:7 row_mask:0xf bank_mask:0xf
    v_and_b32_dpp v157, v12, v33 row_newbcast:7 row_mask:0xf bank_mask:0xf
    v_and_b32_dpp v158, v12, v34 row_newbcast:7 row_mask:0xf bank_mask:0xf
    v_and_b32_dpp v159, v12, v35 row_newbcast:7 row_mask:0xf bank_mask:0xf
    v_and_b32_dpp v160, v12, v32 row_newbcast:8 row_mask:0xf bank_mask:0xf
    v_and_b32_dpp v161, v12, v33 row_newbcast:8 row_mask:0xf bank_mask:0xf
    v_and_b32_dpp v162, v12, v34 row_newbcast:8 row_mask:0xf bank_mask:0xf
    v_and_b32_dpp v163, v12, v35 row_newbcast:8 row_mask:0xf bank_mask:0xf
    v_and_b32_dpp v164, v12, v32 row_newbcast:9 row_mask:0xf bank_mask:0xf
    v_and_b32_dpp v165, v12, v33 row_newbcast:9 row_mask:0xf bank_mask:0xf
    v_and_b32_dpp v166, v12, v34 row_newbcast:9 row_mask:0xf bank_mask:0xf
    v_and_b32_dpp v167, v12, v35 row_newbcast:9 row_mask:0xf bank_mask:0xf
    v_and_b32_dpp v168, v12, v32 row_newbcast:10 row_mask:0xf bank_mask:0xf
    v_and_b32_dpp v169, v12, v33 row_newbcast:10 row_mask:0xf bank_mask:0xf
    v_and_b32_dpp v170, v12, v34 row_newbcast:10 row_mask:0xf bank_mask:0xf
    v_and_b32_dpp v171, v12, v35 row_newbcast:10 row_mask:0xf bank_mask:0xf
    v_and_b32_dpp v172, v12, v32 row_newbcast:11 row_mask:0xf bank_mask:0xf
    v_and_b32_dpp v173, v12, v33 row_newbcast:11 row_mask:0xf bank_mask:0xf
    v_and_b32_dpp v174, v12, v34 row_newbcast:11 row_mask:0xf bank_mask:0xf
    v_and_b32_dpp v175, v12, v35 row_newbcast:11 row_mask:0xf bank_mask:0xf
    v_and_b32_dpp v176, v12, v32 row_newbcast:12 row_mask:0xf bank_mask:0xf
    v_and_b32_dpp v177, v12, v33 row_newbcast:12 row_mask:0xf bank_mask:0xf
    v_and_b32_dpp v178, v12, v34 row_newbcast:12 row_mask:0xf bank_mask:0xf
    v_and_b32_dpp v179, v12, v35 row_newbcast:12 row_mask:0xf bank_mask:0xf
    v_and_b32_dpp v180, v12, v32 row_newbcast:13 row_mask:0xf bank_mask:0xf
    v_and_b32_dpp v181, v12, v33 row_newbcast:13 row_mask:0xf bank_mask:0xf
    v_and_b32_dpp v182, v12, v34 row_newbcast:13 row_mask:0xf bank_mask:0xf
    v_and_b32_dpp v183, v12, v35 row_newbcast:13 row_mask:0xf bank_mask:0xf
    v_and_b32_dpp v184, v12, v32 row_newbcast:14 row_mask:0xf bank_mask:0xf
    v_and_b32_dpp v185, v12, v33 row_newbcast:14 row_mask:0xf bank_mask:0xf
    v_and_b32_dpp v186, v12, v34 row_newbcast:14 row_mask:0xf bank_mask:0xf
    v_and_b32_dpp v187, v12, v35 row_newbcast:14 row_mask:0xf bank_mask:0xf
    v_and_b32_dpp v188, v12, v32 row_newbcast:15 row_mask:0xf bank_mask:0xf
    v_and_b32_dpp v189, v12, v33 row_newbcast:15 row_mask:0xf bank_mask:0xf
    v_and_b32_dpp v190, v12, v34 row_newbcast:15 row_mask:0xf bank_mask:0xf
    v_and_b32_dpp v191, v12, v35 row_newbcast:15 row_mask:0xf bank_mask:0xf
    buffer_load_dwordx4 v[96:99], v6, s[48:51], s10 offen
    s_add_u32 s10, s10, s12
    buffer_load_dwordx4 v[100:103], v6, s[48:51], s10 offen
    s_add_u32 s10, s10, s12
    buffer_load_dwordx4 v[104:107], v6, s[48:51], s10 offen
    s_add_u32 s10, s10, s12
    buffer_load_dwordx4 v[108:111], v6, s[48:51], s10 offen
    s_cmp_eq_u32 s8, 1
    s_cselect_b32 s13, 4294844416, s12
    s_add_u32 s10, s10, s13
    buffer_load_dwordx4 v[112:115], v6, s[48:51], s10 offen
    s_add_u32 s10, s10, s12
    buffer_load_dwordx4 v[116:119], v6, s[48:51], s10 offen
    s_add_u32 s10, s10, s12
    buffer_load_dwordx4 v[120:123], v6, s[48:51], s10 offen
    s_add_u32 s10, s10, s12
    buffer_load_dwordx4 v[124:127], v6, s[48:51], s10 offen
    s_mov_b32 s54, 4194304
    s_mov_b32 s55, 0x20000
    s_lshl3_add_u32 s13, s8, s3
    s_lshl_b32 s13, s13, 17
    s_add_u32 s13, s13, s17
    s_lshl_b32 s14, s3, 12
    s_add_u32 m0, s14, 131072
    v_lshlrev_b32 v50, 2, v3
    v_xor_b32 v50, v50, v2
    v_lshlrev_b32 v50, 4, v50
    v_lshl_add_u32 v48, v3, 13, v50
    buffer_load_dwordx4 v48, s[52:55], s13 offen nt lds
    v_xor_b32 v49, 16, v48
    s_addk_i32 m0, 0x400
    s_add_u32 s13, s13, 0x8000
    buffer_load_dwordx4 v49, s[52:55], s13 offen nt lds
    v_xor_b32 v49, 32, v48
    s_addk_i32 m0, 0x400
    s_add_u32 s13, s13, 0x8000
    buffer_load_dwordx4 v49, s[52:55], s13 offen nt lds
    v_xor_b32 v49, 48, v48
    s_addk_i32 m0, 0x400
    s_add_u32 s13, s13, 0x8000
    buffer_load_dwordx4 v49, s[52:55], s13 offen nt lds
    s_lshl_b32 s12, s3, 9
    v_add_u32 v42, s12, v41
    s_waitcnt vmcnt(19)
    v_mfma_f32_16x16x32_bf16 v[44:47], v[128:131], v[64:67], 0
    s_waitcnt vmcnt(18)
    v_mfma_f32_16x16x32_bf16 v[44:47], v[132:135], v[68:71], v[44:47]
    s_waitcnt vmcnt(17)
    v_mfma_f32_16x16x32_bf16 v[44:47], v[136:139], v[72:75], v[44:47]
    s_waitcnt vmcnt(16)
    v_mfma_f32_16x16x32_bf16 v[44:47], v[140:143], v[76:79], v[44:47]
    s_waitcnt vmcnt(15)
    v_mfma_f32_16x16x32_bf16 v[44:47], v[144:147], v[80:83], v[44:47]
    s_waitcnt vmcnt(14)
    v_mfma_f32_16x16x32_bf16 v[44:47], v[148:151], v[84:87], v[44:47]
    s_waitcnt vmcnt(13)
    v_mfma_f32_16x16x32_bf16 v[44:47], v[152:155], v[88:91], v[44:47]
    s_waitcnt vmcnt(12)
    v_mfma_f32_16x16x32_bf16 v[44:47], v[156:159], v[92:95], v[44:47]
    s_waitcnt vmcnt(11)
    v_mfma_f32_16x16x32_bf16 v[44:47], v[160:163], v[96:99], v[44:47]
    s_waitcnt vmcnt(10)
    v_mfma_f32_16x16x32_bf16 v[44:47], v[164:167], v[100:103], v[44:47]
    s_waitcnt vmcnt(9)
    v_mfma_f32_16x16x32_bf16 v[44:47], v[168:171], v[104:107], v[44:47]
    s_waitcnt vmcnt(8)
    v_mfma_f32_16x16x32_bf16 v[44:47], v[172:175], v[108:111], v[44:47]
    s_waitcnt vmcnt(7)
    v_mfma_f32_16x16x32_bf16 v[44:47], v[176:179], v[112:115], v[44:47]
    s_waitcnt vmcnt(6)
    v_mfma_f32_16x16x32_bf16 v[44:47], v[180:183], v[116:119], v[44:47]
    s_waitcnt vmcnt(5)
    v_mfma_f32_16x16x32_bf16 v[44:47], v[184:187], v[120:123], v[44:47]
    s_waitcnt vmcnt(4)
    v_mfma_f32_16x16x32_bf16 v[44:47], v[188:191], v[124:127], v[44:47]
    s_waitcnt lgkmcnt(0)
    s_add_u32 s20, s35, 1
    s_add_u32 s21, s35, 2
    s_add_u32 s22, s35, 3
    s_add_u32 s23, s35, 4
    s_and_b32 s24, s20, 3
    s_mul_i32 s24, s24, 0x8001
    s_and_b32 s24, s24, 0x10001
    s_and_b32 s25, s21, 3
    s_mul_i32 s25, s25, 0x8001
    s_and_b32 s25, s25, 0x10001
    s_and_b32 s26, s22, 3
    s_mul_i32 s26, s26, 0x8001
    s_and_b32 s26, s26, 0x10001
    s_and_b32 s27, s23, 3
    s_mul_i32 s27, s27, 0x8001
    s_and_b32 s27, s27, 0x10001
    s_mov_b32 exec_hi, 0
    ds_write_b128 v42, v[44:47] offset:0
    s_mov_b64 exec, -1
    s_sub_u32 s9, s3, 5
    s_cmp_lt_u32 s9, 2
    s_cbranch_scc1 L_A2
    s_waitcnt vmcnt(0) lgkmcnt(0)
    s_barrier
    s_cmp_lt_u32 s3, 4
    s_cbranch_scc1 L_S1
    s_branch L_WO
L_A2:
    s_lshl_b32 s12, s9, 14
    s_add_u32 s12, s12, 131072
    v_and_b32 v4, 3, v0
    v_bfe_u32 v5, v0, 2, 2
    v_lshl_or_b32 v6, v4, 2, v5
    v_xor_b32 v6, v6, v3
    v_lshlrev_b32 v6, 4, v6
    v_lshl_add_u32 v6, v5, 10, v6
    v_lshl_add_u32 v6, v4, 8, v6
    v_add_u32 v10, s12, v6
    v_xor_b32 v11, 64, v10
    v_xor_b32 v12, 0x80, v10
    v_xor_b32 v13, 0xc0, v10
    s_lshl_b32 s13, s9, 8
    s_add_u32 s13, s13, 8192
    v_lshl_add_u32 v5, v3, 4, s13
    v_and_b32 v14, 31, v0
    v_lshl_add_u32 v14, v14, 3, s13
    v_lshlrev_b32 v15, 4, v0
    s_lshl1_add_u32 s11, s8, s9
    s_lshl_b32 s11, s11, 7
    s_lshl_b32 s10, s7, 10
    s_add_u32 s10, s10, s11
    s_add_u32 s10, s10, 262144
    v_lshlrev_b32 v4, 1, v0
    v_cmp_eq_u32 s[14:15], 1, v3
    v_cmp_eq_u32 s[16:17], 2, v3
    v_cmp_eq_u32 s[18:19], 3, v3
    v_bfe_u32 v7, v0, 1, 2
    v_add_u32 v7, s20, v7
    v_and_b32 v8, 1, v0
    v_lshrrev_b32 v7, v8, v7
    v_and_b32 v7, 1, v7
    s_waitcnt vmcnt(0) lgkmcnt(0)
    s_barrier
    ds_read_b128 v[128:131], v15 offset:0
    ds_read_b128 v[132:135], v15 offset:1024
    ds_read_b128 v[136:139], v15 offset:2048
    ds_read_b128 v[140:143], v15 offset:3072
    ds_read_b128 v[64:67], v10 offset:0
    ds_read_b128 v[80:83], v10 offset:4096
    ds_read_b128 v[96:99], v10 offset:8192
    ds_read_b128 v[112:115], v10 offset:12288
    ds_read_b128 v[68:71], v11 offset:0
    ds_read_b128 v[84:87], v11 offset:4096
    ds_read_b128 v[100:103], v11 offset:8192
    ds_read_b128 v[116:119], v11 offset:12288
    ds_read_b128 v[72:75], v12 offset:0
    ds_read_b128 v[88:91], v12 offset:4096
    ds_read_b128 v[104:107], v12 offset:8192
    s_waitcnt lgkmcnt(11)
    v_pk_add_f32 v[128:129], v[128:129], v[132:133]
    v_pk_add_f32 v[130:131], v[130:131], v[134:135]
    v_pk_add_f32 v[136:137], v[136:137], v[140:141]
    v_pk_add_f32 v[138:139], v[138:139], v[142:143]
    v_pk_add_f32 v[128:129], v[128:129], v[136:137]
    v_pk_add_f32 v[130:131], v[130:131], v[138:139]
    v_mov_b32 v132, v128
    v_mov_b32 v133, v129
    v_mov_b32 v134, v130
    v_mov_b32 v135, v131
    v_permlane32_swap_b32 v132, v128
    v_permlane32_swap_b32 v133, v129
    v_permlane32_swap_b32 v134, v130
    v_permlane32_swap_b32 v135, v131
    v_pk_add_f32 v[128:129], v[128:129], v[132:133]
    v_pk_add_f32 v[130:131], v[130:131], v[134:135]
    v_cvt_pk_bf16_f32 v128, v128, v129
    v_cvt_pk_bf16_f32 v129, v130, v131
    ds_write_b64 v14, v[128:129]
    ds_read_b128 v[16:19], v5 offset:0
    ds_read_b128 v[20:23], v5 offset:64
    ds_read_b128 v[24:27], v5 offset:128
    ds_read_b128 v[28:31], v5 offset:192
    ds_read_b128 v[120:123], v12 offset:12288
    ds_read_b128 v[76:79], v13 offset:0
    ds_read_b128 v[92:95], v13 offset:4096
    ds_read_b128 v[108:111], v13 offset:8192
    ds_read_b128 v[124:127], v13 offset:12288
    s_waitcnt lgkmcnt(8)
    v_mfma_f32_16x16x32_bf16 v[32:35], v[16:19], v[64:67], 0
    v_mfma_f32_16x16x32_bf16 v[36:39], v[16:19], v[80:83], 0
    v_mfma_f32_16x16x32_bf16 v[40:43], v[16:19], v[96:99], 0
    v_mfma_f32_16x16x32_bf16 v[44:47], v[16:19], v[112:115], 0
    s_waitcnt lgkmcnt(7)
    v_mfma_f32_16x16x32_bf16 v[32:35], v[20:23], v[68:71], v[32:35]
    v_mfma_f32_16x16x32_bf16 v[36:39], v[20:23], v[84:87], v[36:39]
    v_mfma_f32_16x16x32_bf16 v[40:43], v[20:23], v[100:103], v[40:43]
    v_mfma_f32_16x16x32_bf16 v[44:47], v[20:23], v[116:119], v[44:47]
    s_waitcnt lgkmcnt(4)
    v_mfma_f32_16x16x32_bf16 v[32:35], v[24:27], v[72:75], v[32:35]
    v_mfma_f32_16x16x32_bf16 v[36:39], v[24:27], v[88:91], v[36:39]
    v_mfma_f32_16x16x32_bf16 v[40:43], v[24:27], v[104:107], v[40:43]
    v_mfma_f32_16x16x32_bf16 v[44:47], v[24:27], v[120:123], v[44:47]
    s_waitcnt lgkmcnt(0)
    v_mfma_f32_16x16x32_bf16 v[32:35], v[28:31], v[76:79], v[32:35]
    v_mfma_f32_16x16x32_bf16 v[36:39], v[28:31], v[92:95], v[36:39]
    v_mfma_f32_16x16x32_bf16 v[40:43], v[28:31], v[108:111], v[40:43]
    v_mfma_f32_16x16x32_bf16 v[44:47], v[28:31], v[124:127], v[44:47]
    s_nop 5
    v_cndmask_b32 v9, v32, v36, s[14:15]
    v_cndmask_b32 v9, v9, v40, s[16:17]
    v_cndmask_b32 v9, v9, v44, s[18:19]
    v_mul_f32 v9, 1040356334, v9
    v_add_u32 v9, 0x10000, v9
    v_lshrrev_b32 v9, 17, v9
    v_lshl_or_b32 v9, v9, 1, v7
    s_nop 0
    buffer_store_short v9, v4, s[56:59], s10 offen sc1
    s_branch L_WO
L_ATT_stub:
    s_branch L_ATT_help
L_ATT:
    s_lshr_b32 s7, s5, 2
    s_mul_i32 s8, s7, 1
    s_add_u32 s8, s8, s4
    s_and_b32 s8, s8, 7
    s_lshl3_add_u32 s7, s7, s8
    s_and_b32 s8, s5, 3
    s_lshl_b32 s17, s7, 8
    v_and_b32 v2, 15, v0
    v_lshrrev_b32 v3, 4, v0
    s_mov_b64 s[52:53], s[50:51]
    s_mov_b64 s[44:45], s[42:43]
    s_lshl4_add_u32 s9, s4, s5
    s_mov_b32 s46, 16777216
    s_mov_b32 s47, 0x20000
    s_mov_b32 s28, 0
    s_mov_b32 s58, 16777216
    s_mov_b32 s59, 0x20000
    v_lshlrev_b32 v41, 5, v2
    v_lshl_add_u32 v41, v3, 4, v41
    s_lshl2_add_u32 s10, s9, s3
    s_lshl_b32 s10, s10, 15
    s_lshl_b32 s11, s3, 13
    v_lshlrev_b32 v4, 2, v3
    v_xor_b32 v4, v4, v2
    v_lshlrev_b32 v4, 4, v4
    v_lshl_add_u32 v32, v3, 10, v4
    v_xor_b32 v33, 32, v32
    v_xor_b32 v34, 16, v32
    v_xor_b32 v35, 48, v32
    s_mov_b32 m0, s11
    s_nop 0
    global_load_dword v127, v126, s[52:53]
    s_mov_b32 s15, 0x8000
    s_lshl_b32 s16, s3, 11
    s_add_u32 s16, s16, 131072
    v_mov_b32 v125, s16
    v_mov_b32 v124, 0
    ds_write_b32 v125, v124
    s_load_dword s35, s[56:57], 0
    v_and_b32 v4, 3, v0
    v_lshrrev_b32 v1, 5, v0
    v_bfe_u32 v5, v0, 2, 1
    v_lshl_or_b32 v5, v4, 1, v5
    v_bfe_u32 v6, v0, 3, 1
    v_lshl_or_b32 v5, v5, 1, v6
    v_xor_b32 v5, v5, v1
    v_lshlrev_b32 v5, 4, v5
    v_bfe_u32 v6, v0, 2, 3
    v_lshl_add_u32 v5, v6, 10, v5
    v_lshl_add_u32 v5, v4, 8, v5
    v_add_u32 v8, s11, v5
    v_xor_b32 v5, v2, v1
    v_lshlrev_b32 v5, 4, v5
    v_and_b32 v4, 31, v0
    v_lshl_add_u32 v5, v4, 8, v5
    v_add_u32 v16, 131072, v5
    v_xor_b32 v9, 32, v8
    v_xor_b32 v17, 32, v16
    v_xor_b32 v10, 64, v8
    v_xor_b32 v18, 64, v16
    v_xor_b32 v11, 96, v8
    v_xor_b32 v19, 96, v16
    v_xor_b32 v12, 128, v8
    v_xor_b32 v20, 128, v16
    v_xor_b32 v13, 160, v8
    v_xor_b32 v21, 160, v16
    v_xor_b32 v14, 192, v8
    v_xor_b32 v22, 192, v16
    v_xor_b32 v15, 224, v8
    v_xor_b32 v23, 224, v16
    v_add_u32 v24, 0x10000, v8
    v_add_u32 v25, 0x10000, v9
    v_add_u32 v26, 0x10000, v10
    v_add_u32 v27, 0x10000, v11
    v_add_u32 v28, 0x10000, v12
    v_add_u32 v29, 0x10000, v13
    v_add_u32 v30, 0x10000, v14
    v_add_u32 v31, 0x10000, v15
    v_lshlrev_b32 v6, 4, v4
    v_add_u32 v96, 139264, v6
    v_lshl_add_u32 v6, v1, 9, v6
    s_lshl2_add_u32 s13, s3, 139264
    v_add_u32 v97, s13, v6
    s_lshl_b32 s13, s3, 11
    s_add_u32 s13, s13, 131072
    v_lshl_add_u32 v99, v0, 4, s13
    s_waitcnt lgkmcnt(0)
    s_add_u32 s20, s35, 1
    s_add_u32 s21, s35, 2
    s_add_u32 s22, s35, 3
    s_add_u32 s23, s35, 4
    s_waitcnt vmcnt(1)
    buffer_load_dwordx4 v32, s[44:47], s10 offen nt lds
    s_add_u32 m0, m0, s15
    s_addk_i32 s10, 256
    buffer_load_dwordx4 v32, s[44:47], s10 offen nt lds
    s_add_u32 m0, m0, s15
    s_addk_i32 s10, 256
    buffer_load_dwordx4 v32, s[44:47], s10 offen nt lds
    s_add_u32 m0, m0, s15
    s_addk_i32 s10, 256
    buffer_load_dwordx4 v32, s[44:47], s10 offen nt lds
    s_add_u32 m0, m0, 4294870016
    s_addk_i32 s10, 3328
    s_waitcnt vmcnt(4)
    buffer_load_dwordx4 v33, s[44:47], s10 offen nt lds
    s_add_u32 m0, m0, s15
    s_addk_i32 s10, 256
    buffer_load_dwordx4 v33, s[44:47], s10 offen nt lds
    s_add_u32 m0, m0, s15
    s_addk_i32 s10, 256
    buffer_load_dwordx4 v33, s[44:47], s10 offen nt lds
    s_add_u32 m0, m0, s15
    s_addk_i32 s10, 256
    buffer_load_dwordx4 v33, s[44:47], s10 offen nt lds
    s_add_u32 m0, m0, 4294870016
    s_addk_i32 s10, 3328
    buffer_load_dwordx4 v34, s[44:47], s10 offen nt lds
    s_add_u32 m0, m0, s15
    s_addk_i32 s10, 256
    buffer_load_dwordx4 v34, s[44:47], s10 offen nt lds
    s_add_u32 m0, m0, s15
    s_addk_i32 s10, 256
    s_waitcnt vmcnt(9)
    buffer_load_dwordx4 v34, s[44:47], s10 offen nt lds
    s_add_u32 m0, m0, s15
    s_addk_i32 s10, 256
    s_waitcnt vmcnt(9)
    buffer_load_dwordx4 v34, s[44:47], s10 offen nt lds
    s_add_u32 m0, m0, 4294870016
    s_addk_i32 s10, 3328
    s_barrier
    s_waitcnt vmcnt(9)
    buffer_load_dwordx4 v35, s[44:47], s10 offen nt lds
    s_add_u32 m0, m0, s15
    s_addk_i32 s10, 256
    s_waitcnt vmcnt(9)
    buffer_load_dwordx4 v35, s[44:47], s10 offen nt lds
    s_add_u32 m0, m0, s15
    s_addk_i32 s10, 256
    s_waitcnt vmcnt(9)
    buffer_load_dwordx4 v35, s[44:47], s10 offen nt lds
    s_add_u32 m0, m0, s15
    s_addk_i32 s10, 256
    s_waitcnt vmcnt(9)
    buffer_load_dwordx4 v35, s[44:47], s10 offen nt lds
    s_add_u32 m0, m0, 4294870016
    s_addk_i32 s10, 3328
    s_waitcnt vmcnt(9)
    buffer_load_dwordx4 v32, s[44:47], s10 offen nt lds
    s_add_u32 m0, m0, s15
    s_addk_i32 s10, 256
    s_waitcnt vmcnt(9)
    buffer_load_dwordx4 v32, s[44:47], s10 offen nt lds
    s_add_u32 m0, m0, s15
    s_addk_i32 s10, 256
    s_waitcnt vmcnt(9)
    buffer_load_dwordx4 v32, s[44:47], s10 offen nt lds
    s_add_u32 m0, m0, s15
    s_addk_i32 s10, 256
    s_waitcnt vmcnt(9)
    buffer_load_dwordx4 v32, s[44:47], s10 offen nt lds
    s_add_u32 m0, m0, 4294870016
    s_addk_i32 s10, 3328
    s_waitcnt vmcnt(9)
    buffer_load_dwordx4 v33, s[44:47], s10 offen nt lds
    s_add_u32 m0, m0, s15
    s_addk_i32 s10, 256
    s_waitcnt vmcnt(9)
    buffer_load_dwordx4 v33, s[44:47], s10 offen nt lds
    s_add_u32 m0, m0, s15
    s_addk_i32 s10, 256
    s_waitcnt vmcnt(9)
    buffer_load_dwordx4 v33, s[44:47], s10 offen nt lds
    s_add_u32 m0, m0, s15
    s_addk_i32 s10, 256
    s_waitcnt vmcnt(9)
    buffer_load_dwordx4 v33, s[44:47], s10 offen nt lds
    s_add_u32 m0, m0, 4294870016
    s_addk_i32 s10, 3328
    s_waitcnt vmcnt(9)
    buffer_load_dwordx4 v34, s[44:47], s10 offen nt lds
    s_add_u32 m0, m0, s15
    s_addk_i32 s10, 256
    s_waitcnt vmcnt(9)
    buffer_load_dwordx4 v34, s[44:47], s10 offen nt lds
    s_add_u32 m0, m0, s15
    s_addk_i32 s10, 256
    s_waitcnt vmcnt(9)
    buffer_load_dwordx4 v34, s[44:47], s10 offen nt lds
    s_add_u32 m0, m0, s15
    s_addk_i32 s10, 256
    s_waitcnt vmcnt(9)
    buffer_load_dwordx4 v34, s[44:47], s10 offen nt lds
    s_add_u32 m0, m0, 4294870016
    s_addk_i32 s10, 3328
    s_waitcnt vmcnt(9)
    buffer_load_dwordx4 v35, s[44:47], s10 offen nt lds
    s_add_u32 m0, m0, s15
    s_addk_i32 s10, 256
    s_waitcnt vmcnt(9)
    buffer_load_dwordx4 v35, s[44:47], s10 offen nt lds
    s_add_u32 m0, m0, s15
    s_addk_i32 s10, 256
    s_waitcnt vmcnt(9)
    buffer_load_dwordx4 v35, s[44:47], s10 offen nt lds
    s_add_u32 m0, m0, s15
    s_addk_i32 s10, 256
    s_waitcnt vmcnt(9)
    buffer_load_dwordx4 v35, s[44:47], s10 offen nt lds
    ds_write_b32 v125, v125
    s_waitcnt vmcnt(3)
    ds_read_b128 v[128:131], v8 offset:0
    ds_read_b128 v[132:135], v9 offset:0
    ds_read_b128 v[136:139], v10 offset:0
    ds_read_b128 v[140:143], v11 offset:0
    ds_read_b128 v[144:147], v12 offset:0
    ds_read_b128 v[148:151], v13 offset:0
    ds_read_b128 v[152:155], v14 offset:0
    ds_read_b128 v[156:159], v15 offset:0
    s_waitcnt vmcnt(2)
    ds_read_b128 v[160:163], v8 offset:32768
    ds_read_b128 v[164:167], v9 offset:32768
    ds_read_b128 v[168:171], v10 offset:32768
    ds_read_b128 v[172:175], v11 offset:32768
    ds_read_b128 v[176:179], v12 offset:32768
    ds_read_b128 v[180:183], v13 offset:32768
    ds_read_b128 v[184:187], v14 offset:32768
    ds_read_b128 v[188:191], v15 offset:32768
    s_waitcnt vmcnt(1)
    ds_read_b128 v[192:195], v24 offset:0
    ds_read_b128 v[196:199], v25 offset:0
    ds_read_b128 v[200:203], v26 offset:0
    ds_read_b128 v[204:207], v27 offset:0
    ds_read_b128 v[208:211], v28 offset:0
    ds_read_b128 v[212:215], v29 offset:0
    ds_read_b128 v[216:219], v30 offset:0
    ds_read_b128 v[220:223], v31 offset:0
    s_waitcnt vmcnt(0)
    ds_read_b128 v[224:227], v24 offset:32768
    ds_read_b128 v[228:231], v25 offset:32768
    ds_read_b128 v[232:235], v26 offset:32768
    ds_read_b128 v[236:239], v27 offset:32768
    ds_read_b128 v[240:243], v28 offset:32768
    ds_read_b128 v[244:247], v29 offset:32768
    ds_read_b128 v[248:251], v30 offset:32768
    ds_read_b128 v[252:255], v31 offset:32768
    s_setprio 2
    s_barrier
    ds_read_b128 v[32:35], v16 offset:0
    ds_read_b128 v[36:39], v17 offset:0
    ds_read_b128 v[40:43], v18 offset:0
    ds_read_b128 v[44:47], v19 offset:0
    ds_read_b128 v[48:51], v20 offset:0
    ds_read_b128 v[52:55], v21 offset:0
    s_waitcnt lgkmcnt(5)
    v_mfma_f32_32x32x16_bf16 v[64:79], v[128:131], v[32:35], 0
    ds_read_b128 v[56:59], v22 offset:0
    s_waitcnt lgkmcnt(5)
    v_mfma_f32_32x32x16_bf16 v[64:79], v[132:135], v[36:39], v[64:79]
    ds_read_b128 v[60:63], v23 offset:0
    s_waitcnt lgkmcnt(5)
    v_mfma_f32_32x32x16_bf16 v[64:79], v[136:139], v[40:43], v[64:79]
    ds_read_b128 v[32:35], v16 offset:8192
    s_waitcnt lgkmcnt(5)
    v_mfma_f32_32x32x16_bf16 v[64:79], v[140:143], v[44:47], v[64:79]
    ds_read_b128 v[36:39], v17 offset:8192
    s_waitcnt lgkmcnt(5)
    v_mfma_f32_32x32x16_bf16 v[64:79], v[144:147], v[48:51], v[64:79]
    ds_read_b128 v[40:43], v18 offset:8192
    s_waitcnt lgkmcnt(5)
    v_mfma_f32_32x32x16_bf16 v[64:79], v[148:151], v[52:55], v[64:79]
    ds_read_b128 v[44:47], v19 offset:8192
    s_waitcnt lgkmcnt(5)
    v_mfma_f32_32x32x16_bf16 v[64:79], v[152:155], v[56:59], v[64:79]
    ds_read_b128 v[48:51], v20 offset:8192
    s_waitcnt lgkmcnt(5)
    v_mfma_f32_32x32x16_bf16 v[64:79], v[156:159], v[60:63], v[64:79]
    ds_read_b128 v[52:55], v21 offset:8192
    s_waitcnt lgkmcnt(5)
    v_mfma_f32_32x32x16_bf16 v[64:79], v[160:163], v[32:35], v[64:79]
    ds_read_b128 v[56:59], v22 offset:8192
    s_waitcnt lgkmcnt(5)
    v_mfma_f32_32x32x16_bf16 v[64:79], v[164:167], v[36:39], v[64:79]
    s_barrier
    ds_read_b128 v[60:63], v23 offset:8192
    s_waitcnt lgkmcnt(5)
    v_mfma_f32_32x32x16_bf16 v[64:79], v[168:171], v[40:43], v[64:79]
    ds_read_b128 v[32:35], v16 offset:16384
    s_waitcnt lgkmcnt(5)
    v_mfma_f32_32x32x16_bf16 v[64:79], v[172:175], v[44:47], v[64:79]
    ds_read_b128 v[36:39], v17 offset:16384
    s_waitcnt lgkmcnt(5)
    v_mfma_f32_32x32x16_bf16 v[64:79], v[176:179], v[48:51], v[64:79]
    ds_read_b128 v[40:43], v18 offset:16384
    s_waitcnt lgkmcnt(5)
    v_mfma_f32_32x32x16_bf16 v[64:79], v[180:183], v[52:55], v[64:79]
    ds_read_b128 v[44:47], v19 offset:16384
    s_waitcnt lgkmcnt(5)
    v_mfma_f32_32x32x16_bf16 v[64:79], v[184:187], v[56:59], v[64:79]
    ds_read_b128 v[48:51], v20 offset:16384
    s_waitcnt lgkmcnt(5)
    v_mfma_f32_32x32x16_bf16 v[64:79], v[188:191], v[60:63], v[64:79]
    ds_read_b128 v[52:55], v21 offset:16384
    s_waitcnt lgkmcnt(5)
    v_mfma_f32_32x32x16_bf16 v[64:79], v[192:195], v[32:35], v[64:79]
    ds_read_b128 v[56:59], v22 offset:16384
    s_waitcnt lgkmcnt(5)
    v_mfma_f32_32x32x16_bf16 v[64:79], v[196:199], v[36:39], v[64:79]
    ds_read_b128 v[60:63], v23 offset:16384
    s_waitcnt lgkmcnt(5)
    v_mfma_f32_32x32x16_bf16 v[64:79], v[200:203], v[40:43], v[64:79]
    ds_read_b128 v[32:35], v16 offset:24576
    s_waitcnt lgkmcnt(5)
    v_mfma_f32_32x32x16_bf16 v[64:79], v[204:207], v[44:47], v[64:79]
    ds_read_b128 v[36:39], v17 offset:24576
    s_waitcnt lgkmcnt(5)
    v_mfma_f32_32x32x16_bf16 v[64:79], v[208:211], v[48:51], v[64:79]
    ds_read_b128 v[40:43], v18 offset:24576
    s_waitcnt lgkmcnt(5)
    v_mfma_f32_32x32x16_bf16 v[64:79], v[212:215], v[52:55], v[64:79]
    ds_read_b128 v[44:47], v19 offset:24576
    s_waitcnt lgkmcnt(5)
    v_mfma_f32_32x32x16_bf16 v[64:79], v[216:219], v[56:59], v[64:79]
    ds_read_b128 v[48:51], v20 offset:24576
    s_waitcnt lgkmcnt(5)
    v_mfma_f32_32x32x16_bf16 v[64:79], v[220:223], v[60:63], v[64:79]
    ds_read_b128 v[52:55], v21 offset:24576
    s_waitcnt lgkmcnt(5)
    v_mfma_f32_32x32x16_bf16 v[64:79], v[224:227], v[32:35], v[64:79]
    ds_read_b128 v[56:59], v22 offset:24576
    s_waitcnt lgkmcnt(5)
    v_mfma_f32_32x32x16_bf16 v[64:79], v[228:231], v[36:39], v[64:79]
    ds_read_b128 v[60:63], v23 offset:24576
    s_waitcnt lgkmcnt(5)
    v_mfma_f32_32x32x16_bf16 v[64:79], v[232:235], v[40:43], v[64:79]
    s_waitcnt lgkmcnt(4)
    v_mfma_f32_32x32x16_bf16 v[64:79], v[236:239], v[44:47], v[64:79]
    s_waitcnt lgkmcnt(0)
    s_barrier
    v_mfma_f32_32x32x16_bf16 v[64:79], v[240:243], v[48:51], v[64:79]
    v_mfma_f32_32x32x16_bf16 v[64:79], v[244:247], v[52:55], v[64:79]
    v_mfma_f32_32x32x16_bf16 v[64:79], v[248:251], v[56:59], v[64:79]
    v_mfma_f32_32x32x16_bf16 v[64:79], v[252:255], v[60:63], v[64:79]
    s_nop 11
    v_max3_f32 v4, v64, v65, v66
    v_max3_f32 v5, v67, v68, v69
    v_max3_f32 v6, v70, v71, v72
    v_max3_f32 v7, v73, v74, v75
    v_max3_f32 v4, v4, v76, v77
    v_max3_f32 v5, v5, v78, v79
    v_max3_f32 v4, v4, v5, v6
    v_max_f32 v20, v4, v7
    ds_write_b32 v97, v20
    v_pk_add_f32 v[64:65], v[64:65], v[20:21] op_sel_hi:[1,0] neg_lo:[0,1] neg_hi:[0,1]
    v_pk_add_f32 v[66:67], v[66:67], v[20:21] op_sel_hi:[1,0] neg_lo:[0,1] neg_hi:[0,1]
    v_pk_add_f32 v[68:69], v[68:69], v[20:21] op_sel_hi:[1,0] neg_lo:[0,1] neg_hi:[0,1]
    v_pk_add_f32 v[70:71], v[70:71], v[20:21] op_sel_hi:[1,0] neg_lo:[0,1] neg_hi:[0,1]
    v_pk_add_f32 v[72:73], v[72:73], v[20:21] op_sel_hi:[1,0] neg_lo:[0,1] neg_hi:[0,1]
    v_pk_add_f32 v[74:75], v[74:75], v[20:21] op_sel_hi:[1,0] neg_lo:[0,1] neg_hi:[0,1]
    v_pk_add_f32 v[76:77], v[76:77], v[20:21] op_sel_hi:[1,0] neg_lo:[0,1] neg_hi:[0,1]
    v_pk_add_f32 v[78:79], v[78:79], v[20:21] op_sel_hi:[1,0] neg_lo:[0,1] neg_hi:[0,1]
    v_exp_f32 v64, v64
    v_exp_f32 v65, v65
    v_exp_f32 v66, v66
    v_exp_f32 v67, v67
    s_waitcnt lgkmcnt(0)
    s_barrier
    ds_read_b128 v[8:11], v96
    ds_read_b128 v[12:15], v96 offset:512
    v_exp_f32 v68, v68
    v_exp_f32 v69, v69
    v_exp_f32 v70, v70
    v_exp_f32 v71, v71
    v_exp_f32 v72, v72
    v_exp_f32 v73, v73
    v_exp_f32 v74, v74
    v_exp_f32 v75, v75
    v_exp_f32 v76, v76
    v_exp_f32 v77, v77
    v_exp_f32 v78, v78
    v_exp_f32 v79, v79
    s_waitcnt lgkmcnt(0)
    v_max3_f32 v4, v8, v9, v10
    v_max3_f32 v5, v11, v12, v13
    v_max3_f32 v4, v4, v14, v15
    v_max_f32 v8, v4, v5
    v_sub_f32 v20, v20, v8
    v_exp_f32 v20, v20
    s_nop 0
    v_pk_mul_f32 v[64:65], v[64:65], v[20:21] op_sel_hi:[1,0]
    v_pk_mul_f32 v[66:67], v[66:67], v[20:21] op_sel_hi:[1,0]
    v_cvt_pk_bf16_f32 v80, v64, v65
    v_cvt_pk_bf16_f32 v81, v66, v67
    ds_write_b64 v99, v[80:81] offset:0
    v_pk_mul_f32 v[68:69], v[68:69], v[20:21] op_sel_hi:[1,0]
    v_pk_mul_f32 v[70:71], v[70:71], v[20:21] op_sel_hi:[1,0]
    v_cvt_pk_bf16_f32 v82, v68, v69
    v_cvt_pk_bf16_f32 v83, v70, v71
    ds_write_b64 v99, v[82:83] offset:8
    v_pk_mul_f32 v[72:73], v[72:73], v[20:21] op_sel_hi:[1,0]
    v_pk_mul_f32 v[74:75], v[74:75], v[20:21] op_sel_hi:[1,0]
    v_cvt_pk_bf16_f32 v84, v72, v73
    v_cvt_pk_bf16_f32 v85, v74, v75
    ds_write_b64 v99, v[84:85] offset:1024
    v_pk_mul_f32 v[76:77], v[76:77], v[20:21] op_sel_hi:[1,0]
    v_pk_mul_f32 v[78:79], v[78:79], v[20:21] op_sel_hi:[1,0]
    v_cvt_pk_bf16_f32 v86, v76, v77
    v_cvt_pk_bf16_f32 v87, v78, v79
    ds_write_b64 v99, v[86:87] offset:1032
    v_pk_add_f32 v[64:65], v[64:65], v[66:67]
    v_pk_add_f32 v[68:69], v[68:69], v[70:71]
    v_pk_add_f32 v[72:73], v[72:73], v[74:75]
    v_pk_add_f32 v[76:77], v[76:77], v[78:79]
    v_pk_add_f32 v[64:65], v[64:65], v[68:69]
    v_pk_add_f32 v[72:73], v[72:73], v[76:77]
    s_waitcnt lgkmcnt(0)
    s_setprio 0
    s_barrier
    v_add_f32 v64, v64, v65
    v_add_f32 v72, v72, v73
    v_add_f32 v64, v64, v72
    ds_write_b32 v97, v64 offset:1024
    s_waitcnt lgkmcnt(0)
    s_barrier
    s_setprio 0
    s_cmp_lg_u32 s3, 0
    s_cbranch_scc1 L_FIN
    ds_read_b128 v[32:35], v96 offset:1024
    ds_read_b128 v[36:39], v96 offset:1536
    v_lshlrev_b32 v5, 4, v0
    v_mov_b32 v9, s20
    v_mov_b32 v11, s20
    s_lshl_b32 s12, s9, 9
    s_add_u32 s12, s12, 327680
    s_waitcnt lgkmcnt(0)
    v_add_f32 v32, v32, v33
    v_add_f32 v34, v34, v35
    v_add_f32 v36, v36, v37
    v_add_f32 v38, v38, v39
    v_add_f32 v32, v32, v34
    v_add_f32 v36, v36, v38
    v_add_f32 v10, v32, v36
    s_mov_b32 exec_hi, 0
    buffer_store_dwordx4 v[8:11], v5, s[56:59], s12 offen sc1
    s_mov_b64 exec, -1
L_FIN:
    s_cmp_lt_u32 s5, 12
    s_cbranch_scc1 L_exit
    s_sub_u32 s12, 3, s3
    s_cmp_ge_u32 s12, 1
    s_cbranch_scc1 L_exit
    s_load_dwordx2 s[44:45], s[0:1], 80
    s_load_dwordx2 s[48:49], s[0:1], 88
    s_sub_u32 s10, s5, 12
    s_mul_i32 s10, s10, 1
    s_add_u32 s10, s10, s12
    s_lshl2_add_u32 s10, s4, s10
    s_lshl_b32 s11, s10, 6
    s_add_u32 s64, s11, 524288
    s_add_u32 s65, s64, 32768
    s_add_u32 s66, s64, 65536
    s_add_u32 s67, s64, 98304
    s_add_u32 s68, s64, 131072
    s_add_u32 s69, s64, 163840
    s_add_u32 s70, s64, 196608
    s_add_u32 s71, s64, 229376
    s_lshl_b32 s16, s10, 5
    v_lshrrev_b32 v4, 2, v0
    v_and_b32 v5, 3, v0
    v_lshlrev_b32 v4, 11, v4
    v_lshl_add_u32 v4, v5, 4, v4
    v_lshl_add_u32 v5, v5, 2, v3
    v_lshlrev_b32 v5, 1, v5
    v_mov_b32 v6, 0xff
    s_mov_b32 s42, 1024
    s_mov_b32 s43, 0x20000
    s_mov_b32 s46, 1024
    s_mov_b32 s47, 0x20000
    s_mov_b32 s50, 1024
    s_mov_b32 s51, 0x20000
    s_barrier
    s_waitcnt lgkmcnt(0)
    buffer_load_ushort v14, v5, s[40:43], s16 offen
    buffer_load_ushort v15, v5, s[44:47], s16 offen
    s_waitcnt vmcnt(0)
    v_lshlrev_b32 v14, 16, v14
    v_lshlrev_b32 v15, 16, v15
    v_add_f32 v14, v14, v15
    s_and_b32 s72, s20, 0xff
    s_and_b32 s73, s21, 0xff
    s_and_b32 s74, s22, 0xff
    s_and_b32 s75, s23, 0xff
L_fin:
    buffer_load_dwordx4 v[64:67], v4, s[56:59], s64 offen sc1
    buffer_load_dwordx4 v[68:71], v4, s[56:59], s65 offen sc1
    buffer_load_dwordx4 v[72:75], v4, s[56:59], s66 offen sc1
    buffer_load_dwordx4 v[76:79], v4, s[56:59], s67 offen sc1
    buffer_load_dwordx4 v[80:83], v4, s[56:59], s68 offen sc1
    buffer_load_dwordx4 v[84:87], v4, s[56:59], s69 offen sc1
    buffer_load_dwordx4 v[88:91], v4, s[56:59], s70 offen sc1
    buffer_load_dwordx4 v[92:95], v4, s[56:59], s71 offen sc1
    s_waitcnt vmcnt(7)
    v_xor_b32 v64, s72, v64
    v_xor_b32 v66, s74, v66
    v_or3_b32 v7, 0, v64, v66
    s_waitcnt vmcnt(6)
    v_xor_b32 v68, s72, v68
    v_xor_b32 v70, s74, v70
    v_or3_b32 v7, v7, v68, v70
    v_pk_add_f32 v[64:65], v[64:65], v[68:69]
    v_pk_add_f32 v[66:67], v[66:67], v[70:71]
    s_waitcnt vmcnt(5)
    v_xor_b32 v72, s72, v72
    v_xor_b32 v74, s74, v74
    v_or3_b32 v7, v7, v72, v74
    v_pk_add_f32 v[64:65], v[64:65], v[72:73]
    v_pk_add_f32 v[66:67], v[66:67], v[74:75]
    s_waitcnt vmcnt(4)
    v_xor_b32 v76, s72, v76
    v_xor_b32 v78, s74, v78
    v_or3_b32 v7, v7, v76, v78
    v_pk_add_f32 v[64:65], v[64:65], v[76:77]
    v_pk_add_f32 v[66:67], v[66:67], v[78:79]
    s_waitcnt vmcnt(3)
    v_xor_b32 v80, s72, v80
    v_xor_b32 v82, s74, v82
    v_or3_b32 v7, v7, v80, v82
    v_pk_add_f32 v[64:65], v[64:65], v[80:81]
    v_pk_add_f32 v[66:67], v[66:67], v[82:83]
    s_waitcnt vmcnt(2)
    v_xor_b32 v84, s72, v84
    v_xor_b32 v86, s74, v86
    v_or3_b32 v7, v7, v84, v86
    v_pk_add_f32 v[64:65], v[64:65], v[84:85]
    v_pk_add_f32 v[66:67], v[66:67], v[86:87]
    s_waitcnt vmcnt(1)
    v_xor_b32 v88, s72, v88
    v_xor_b32 v90, s74, v90
    v_or3_b32 v7, v7, v88, v90
    v_pk_add_f32 v[64:65], v[64:65], v[88:89]
    v_pk_add_f32 v[66:67], v[66:67], v[90:91]
    s_waitcnt vmcnt(0)
    v_xor_b32 v92, s72, v92
    v_xor_b32 v94, s74, v94
    v_or3_b32 v7, v7, v92, v94
    v_pk_add_f32 v[64:65], v[64:65], v[92:93]
    v_pk_add_f32 v[66:67], v[66:67], v[94:95]
    v_and_b32 v7, v6, v7
    v_cmp_ne_u32 vcc, 0, v7
    v_permlane32_swap_b32 v64, v66
    v_permlane32_swap_b32 v65, v67
    s_add_u32 s28, s28, 1
    s_cmp_gt_u32 s28, 131072
    s_cbranch_scc1 L_exit
    s_cbranch_vccnz L_fin
    v_pk_add_f32 v[64:65], v[64:65], v[66:67]
    s_nop 1
    v_permlane16_swap_b32 v64, v65
    v_add_f32 v64, v64, v65
    s_nop 1
    v_add_f32_dpp v64, v64, v64 row_ror:4 row_mask:0xf bank_mask:0xf
    s_nop 1
    v_add_f32_dpp v64, v64, v64 row_ror:8 row_mask:0xf bank_mask:0xf
    v_add_f32 v64, v64, v14
    v_cvt_pk_bf16_f32 v64, v64, v64
    s_mov_b32 exec_lo, 0x000f000f
    s_mov_b32 exec_hi, 0x000f000f
    buffer_store_short v64, v5, s[48:51], s16 offen
    s_cmp_lg_u32 s10, 0
    s_cbranch_scc1 L_fin_done
    s_mov_b64 exec, 1
    v_mov_b32 v14, s20
    buffer_store_dword v14, v5, s[56:59], 0 offen offset:0
L_fin_done:
    s_mov_b64 exec, -1
    s_branch L_exit
L_ATT_help:
    s_lshr_b32 s7, s5, 2
    s_mul_i32 s8, s7, 1
    s_add_u32 s8, s8, s4
    s_and_b32 s8, s8, 7
    s_lshl3_add_u32 s7, s7, s8
    s_and_b32 s8, s5, 3
    s_lshl_b32 s17, s7, 8
    v_and_b32 v2, 15, v0
    v_lshrrev_b32 v3, 4, v0
    s_mov_b32 s28, 0
    s_mov_b32 s58, 16777216
    s_mov_b32 s59, 0x20000
    v_lshlrev_b32 v41, 5, v2
    v_lshl_add_u32 v41, v3, 4, v41
    s_waitcnt lgkmcnt(0)
    s_load_dword s35, s[56:57], 0
    s_lshl4_add_u32 s9, s4, s5
    s_sub_u32 s10, s3, 4
    s_lshl_b32 s11, s10, 13
    s_add_u32 s12, s11, 262144
    s_lshl_b32 s11, s10, 11
    s_add_u32 s13, s11, 131072
    s_and_b32 s14, s10, 1
    s_lshl_b32 s14, s14, 3
    v_lshlrev_b32 v5, 4, v2
    v_lshl_add_u32 v5, v3, 10, v5
    v_xor_b32 v8, v2, v3
    v_xor_b32 v8, s14, v8
    v_lshlrev_b32 v8, 4, v8
    v_lshl_add_u32 v8, v3, 8, v8
    v_add_u32 v8, s13, v8
    v_xor_b32 v9, 64, v8
    s_add_u32 s19, s12, 4096
    v_mov_b32 v6, 0x10001
    v_bfe_u32 v4, v0, 2, 2
    v_bfe_u32 v7, v0, 4, 1
    v_bfe_u32 v12, v0, 1, 1
    v_lshl_or_b32 v12, v7, 1, v12
    v_lshl_or_b32 v12, v4, 2, v12
    v_lshlrev_b32 v12, 4, v12
    v_lshl_add_u32 v12, v4, 8, v12
    v_lshl_add_u32 v12, v7, 10, v12
    v_lshrrev_b32 v13, 5, v0
    v_lshl_add_u32 v12, v13, 12, v12
    v_and_b32 v4, 1, v0
    v_lshl_add_u32 v12, v4, 3, v12
    s_lshl_b32 s14, s10, 15
    v_add_u32 v24, s14, v12
    v_lshlrev_b32 v4, 4, v2
    v_lshl_add_u32 v1, v3, 19, v4
    v_lshl_add_u32 v4, v7, 9, v4
    v_lshl_add_u32 v4, v13, 10, v4
    v_add_u32 v98, 131072, v4
    s_lshl_b32 s15, s9, 8
    s_add_u32 s14, s14, s15
    s_add_u32 s14, s14, 1048576
    v_xor_b32 v100, 16, v24
    v_xor_b32 v25, 32, v24
    v_xor_b32 v101, 48, v24
    v_xor_b32 v26, 64, v24
    v_xor_b32 v102, 80, v24
    v_xor_b32 v27, 96, v24
    v_xor_b32 v103, 112, v24
    v_xor_b32 v28, 128, v24
    v_xor_b32 v104, 144, v24
    v_xor_b32 v29, 160, v24
    v_xor_b32 v105, 176, v24
    v_xor_b32 v30, 192, v24
    v_xor_b32 v106, 208, v24
    v_xor_b32 v31, 224, v24
    v_xor_b32 v107, 240, v24
    s_add_u32 s64, s14, 0
    s_add_u32 s65, s14, 131072
    s_add_u32 s66, s14, 262144
    s_add_u32 s67, s14, 393216
    s_add_u32 s68, s14, 2097152
    s_add_u32 s69, s14, 2228224
    s_add_u32 s70, s14, 2359296
    s_add_u32 s71, s14, 2490368
    s_waitcnt lgkmcnt(0)
    s_add_u32 s20, s35, 1
    s_add_u32 s21, s35, 2
    s_add_u32 s22, s35, 3
    s_add_u32 s23, s35, 4
    s_and_b32 s24, s20, 3
    s_mul_i32 s24, s24, 0x8001
    s_and_b32 s24, s24, 0x10001
    s_and_b32 s25, s21, 3
    s_mul_i32 s25, s25, 0x8001
    s_and_b32 s25, s25, 0x10001
    s_and_b32 s26, s22, 3
    s_mul_i32 s26, s26, 0x8001
    s_and_b32 s26, s26, 0x10001
    s_and_b32 s27, s23, 3
    s_mul_i32 s27, s27, 0x8001
    s_and_b32 s27, s27, 0x10001
    s_barrier
    v_mov_b32 v16, s13
L_qtrig:
    ds_read_b32 v17, v16
    s_waitcnt lgkmcnt(0)
    v_cmp_eq_u32 vcc, 0, v17
    s_sleep 1
    s_add_u32 s28, s28, 0x10000
    s_cbranch_scc1 L_exit
    s_cbranch_vccnz L_qtrig
    s_and_b32 s28, s28, 0xffff
    s_setprio 3
    buffer_load_dwordx4 v[64:67], v5, s[56:59], s12 offen offset:0 sc1
    buffer_load_dwordx4 v[68:71], v5, s[56:59], s19 offen offset:0 sc1
    buffer_load_dwordx4 v[72:75], v5, s[56:59], s12 offen offset:256 sc1
    buffer_load_dwordx4 v[76:79], v5, s[56:59], s19 offen offset:256 sc1
    buffer_load_dwordx4 v[80:83], v5, s[56:59], s12 offen offset:512 sc1
    buffer_load_dwordx4 v[84:87], v5, s[56:59], s19 offen offset:512 sc1
    buffer_load_dwordx4 v[88:91], v5, s[56:59], s12 offen offset:768 sc1
    buffer_load_dwordx4 v[92:95], v5, s[56:59], s19 offen offset:768 sc1
    s_waitcnt vmcnt(7)
    v_xor_b32 v32, s24, v64
    v_xor_b32 v33, s25, v65
    v_xor_b32 v34, s26, v66
    v_xor_b32 v35, s27, v67
    ds_write_b128 v8, v[32:35] offset:0
    v_or3_b32 v12, v32, v33, v34
    v_or_b32 v12, v12, v35
    s_waitcnt vmcnt(6)
    v_xor_b32 v36, s24, v68
    v_xor_b32 v37, s25, v69
    v_xor_b32 v38, s26, v70
    v_xor_b32 v39, s27, v71
    ds_write_b128 v9, v[36:39] offset:1024
    v_or3_b32 v13, v36, v37, v38
    v_or_b32 v13, v13, v39
    s_waitcnt vmcnt(5)
    v_xor_b32 v40, s24, v72
    v_xor_b32 v41, s25, v73
    v_xor_b32 v42, s26, v74
    v_xor_b32 v43, s27, v75
    ds_write_b128 v8, v[40:43] offset:8192
    v_or3_b32 v14, v40, v41, v42
    v_or_b32 v14, v14, v43
    s_waitcnt vmcnt(4)
    v_xor_b32 v44, s24, v76
    v_xor_b32 v45, s25, v77
    v_xor_b32 v46, s26, v78
    v_xor_b32 v47, s27, v79
    ds_write_b128 v9, v[44:47] offset:9216
    v_or3_b32 v15, v44, v45, v46
    v_or_b32 v15, v15, v47
    v_or3_b32 v7, v12, v13, v14
    v_or_b32 v7, v7, v15
    v_and_b32 v7, v6, v7
    v_cmp_ne_u32 vcc, 0, v7
    s_cbranch_vccz L_qok0
L_qfetch0:
    v_and_b32 v7, v6, v12
    v_cmp_ne_u32 vcc, 0, v7
    s_cbranch_vccz L_qs0
    buffer_load_dwordx4 v[64:67], v5, s[56:59], s12 offen offset:0 sc1
L_qs0:
    v_and_b32 v7, v6, v13
    v_cmp_ne_u32 vcc, 0, v7
    s_cbranch_vccz L_qs1
    buffer_load_dwordx4 v[68:71], v5, s[56:59], s19 offen offset:0 sc1
L_qs1:
    v_and_b32 v7, v6, v14
    v_cmp_ne_u32 vcc, 0, v7
    s_cbranch_vccz L_qs2
    buffer_load_dwordx4 v[72:75], v5, s[56:59], s12 offen offset:256 sc1
L_qs2:
    v_and_b32 v7, v6, v15
    v_cmp_ne_u32 vcc, 0, v7
    s_cbranch_vccz L_qs3
    buffer_load_dwordx4 v[76:79], v5, s[56:59], s19 offen offset:256 sc1
L_qs3:
    s_waitcnt vmcnt(0) lgkmcnt(0)
    v_xor_b32 v32, s24, v64
    v_xor_b32 v33, s25, v65
    v_xor_b32 v34, s26, v66
    v_xor_b32 v35, s27, v67
    ds_write_b128 v8, v[32:35] offset:0
    v_or3_b32 v12, v32, v33, v34
    v_or_b32 v12, v12, v35
    v_xor_b32 v36, s24, v68
    v_xor_b32 v37, s25, v69
    v_xor_b32 v38, s26, v70
    v_xor_b32 v39, s27, v71
    ds_write_b128 v9, v[36:39] offset:1024
    v_or3_b32 v13, v36, v37, v38
    v_or_b32 v13, v13, v39
    v_xor_b32 v40, s24, v72
    v_xor_b32 v41, s25, v73
    v_xor_b32 v42, s26, v74
    v_xor_b32 v43, s27, v75
    ds_write_b128 v8, v[40:43] offset:8192
    v_or3_b32 v14, v40, v41, v42
    v_or_b32 v14, v14, v43
    v_xor_b32 v44, s24, v76
    v_xor_b32 v45, s25, v77
    v_xor_b32 v46, s26, v78
    v_xor_b32 v47, s27, v79
    ds_write_b128 v9, v[44:47] offset:9216
    v_or3_b32 v15, v44, v45, v46
    v_or_b32 v15, v15, v47
    v_or3_b32 v7, v12, v13, v14
    v_or_b32 v7, v7, v15
    v_and_b32 v7, v6, v7
    v_cmp_ne_u32 vcc, 0, v7
    s_add_u32 s28, s28, 1
    s_cmp_gt_u32 s28, 131072
    s_cbranch_scc1 L_exit
    s_cbranch_vccnz L_qfetch0
L_qok0:
    s_waitcnt lgkmcnt(0)
    s_barrier
    s_waitcnt vmcnt(3)
    v_xor_b32 v48, s24, v80
    v_xor_b32 v49, s25, v81
    v_xor_b32 v50, s26, v82
    v_xor_b32 v51, s27, v83
    ds_write_b128 v8, v[48:51] offset:16384
    v_or3_b32 v12, v48, v49, v50
    v_or_b32 v12, v12, v51
    s_waitcnt vmcnt(2)
    v_xor_b32 v52, s24, v84
    v_xor_b32 v53, s25, v85
    v_xor_b32 v54, s26, v86
    v_xor_b32 v55, s27, v87
    ds_write_b128 v9, v[52:55] offset:17408
    v_or3_b32 v13, v52, v53, v54
    v_or_b32 v13, v13, v55
    s_waitcnt vmcnt(1)
    v_xor_b32 v56, s24, v88
    v_xor_b32 v57, s25, v89
    v_xor_b32 v58, s26, v90
    v_xor_b32 v59, s27, v91
    ds_write_b128 v8, v[56:59] offset:24576
    v_or3_b32 v14, v56, v57, v58
    v_or_b32 v14, v14, v59
    s_waitcnt vmcnt(0)
    v_xor_b32 v60, s24, v92
    v_xor_b32 v61, s25, v93
    v_xor_b32 v62, s26, v94
    v_xor_b32 v63, s27, v95
    ds_write_b128 v9, v[60:63] offset:25600
    v_or3_b32 v15, v60, v61, v62
    v_or_b32 v15, v15, v63
    v_or3_b32 v7, v12, v13, v14
    v_or_b32 v7, v7, v15
    v_and_b32 v7, v6, v7
    v_cmp_ne_u32 vcc, 0, v7
    s_cbranch_vccz L_qok1
L_qfetch1:
    v_and_b32 v7, v6, v12
    v_cmp_ne_u32 vcc, 0, v7
    s_cbranch_vccz L_qs4
    buffer_load_dwordx4 v[80:83], v5, s[56:59], s12 offen offset:512 sc1
L_qs4:
    v_and_b32 v7, v6, v13
    v_cmp_ne_u32 vcc, 0, v7
    s_cbranch_vccz L_qs5
    buffer_load_dwordx4 v[84:87], v5, s[56:59], s19 offen offset:512 sc1
L_qs5:
    v_and_b32 v7, v6, v14
    v_cmp_ne_u32 vcc, 0, v7
    s_cbranch_vccz L_qs6
    buffer_load_dwordx4 v[88:91], v5, s[56:59], s12 offen offset:768 sc1
L_qs6:
    v_and_b32 v7, v6, v15
    v_cmp_ne_u32 vcc, 0, v7
    s_cbranch_vccz L_qs7
    buffer_load_dwordx4 v[92:95], v5, s[56:59], s19 offen offset:768 sc1
L_qs7:
    s_waitcnt vmcnt(0) lgkmcnt(0)
    v_xor_b32 v48, s24, v80
    v_xor_b32 v49, s25, v81
    v_xor_b32 v50, s26, v82
    v_xor_b32 v51, s27, v83
    ds_write_b128 v8, v[48:51] offset:16384
    v_or3_b32 v12, v48, v49, v50
    v_or_b32 v12, v12, v51
    v_xor_b32 v52, s24, v84
    v_xor_b32 v53, s25, v85
    v_xor_b32 v54, s26, v86
    v_xor_b32 v55, s27, v87
    ds_write_b128 v9, v[52:55] offset:17408
    v_or3_b32 v13, v52, v53, v54
    v_or_b32 v13, v13, v55
    v_xor_b32 v56, s24, v88
    v_xor_b32 v57, s25, v89
    v_xor_b32 v58, s26, v90
    v_xor_b32 v59, s27, v91
    ds_write_b128 v8, v[56:59] offset:24576
    v_or3_b32 v14, v56, v57, v58
    v_or_b32 v14, v14, v59
    v_xor_b32 v60, s24, v92
    v_xor_b32 v61, s25, v93
    v_xor_b32 v62, s26, v94
    v_xor_b32 v63, s27, v95
    ds_write_b128 v9, v[60:63] offset:25600
    v_or3_b32 v15, v60, v61, v62
    v_or_b32 v15, v15, v63
    v_or3_b32 v7, v12, v13, v14
    v_or_b32 v7, v7, v15
    v_and_b32 v7, v6, v7
    v_cmp_ne_u32 vcc, 0, v7
    s_add_u32 s28, s28, 1
    s_cmp_gt_u32 s28, 131072
    s_cbranch_scc1 L_exit
    s_cbranch_vccnz L_qfetch1
L_qok1:
    s_waitcnt lgkmcnt(0)
    s_setprio 0
    ds_read_b64_tr_b16 v[128:129], v24 offset:0
    ds_read_b64_tr_b16 v[130:131], v100 offset:2048
    ds_read_b64_tr_b16 v[132:133], v24 offset:8192
    ds_read_b64_tr_b16 v[134:135], v100 offset:10240
    s_barrier
    ds_read_b64_tr_b16 v[136:137], v24 offset:16384
    ds_read_b64_tr_b16 v[138:139], v100 offset:18432
    ds_read_b64_tr_b16 v[140:141], v24 offset:24576
    ds_read_b64_tr_b16 v[142:143], v100 offset:26624
    ds_read_b64_tr_b16 v[144:145], v25 offset:0
    ds_read_b64_tr_b16 v[146:147], v101 offset:2048
    ds_read_b64_tr_b16 v[148:149], v25 offset:8192
    ds_read_b64_tr_b16 v[150:151], v101 offset:10240
    ds_read_b64_tr_b16 v[152:153], v25 offset:16384
    ds_read_b64_tr_b16 v[154:155], v101 offset:18432
    ds_read_b64_tr_b16 v[156:157], v25 offset:24576
    ds_read_b64_tr_b16 v[158:159], v101 offset:26624
    ds_read_b64_tr_b16 v[160:161], v26 offset:0
    ds_read_b64_tr_b16 v[162:163], v102 offset:2048
    ds_read_b64_tr_b16 v[164:165], v26 offset:8192
    ds_read_b64_tr_b16 v[166:167], v102 offset:10240
    ds_read_b64_tr_b16 v[168:169], v26 offset:16384
    ds_read_b64_tr_b16 v[170:171], v102 offset:18432
    ds_read_b64_tr_b16 v[172:173], v26 offset:24576
    ds_read_b64_tr_b16 v[174:175], v102 offset:26624
    ds_read_b64_tr_b16 v[176:177], v27 offset:0
    ds_read_b64_tr_b16 v[178:179], v103 offset:2048
    ds_read_b64_tr_b16 v[180:181], v27 offset:8192
    ds_read_b64_tr_b16 v[182:183], v103 offset:10240
    s_barrier
    ds_read_b64_tr_b16 v[184:185], v27 offset:16384
    ds_read_b64_tr_b16 v[186:187], v103 offset:18432
    ds_read_b64_tr_b16 v[188:189], v27 offset:24576
    ds_read_b64_tr_b16 v[190:191], v103 offset:26624
    ds_read_b64_tr_b16 v[192:193], v28 offset:0
    ds_read_b64_tr_b16 v[194:195], v104 offset:2048
    ds_read_b64_tr_b16 v[196:197], v28 offset:8192
    ds_read_b64_tr_b16 v[198:199], v104 offset:10240
    ds_read_b64_tr_b16 v[200:201], v28 offset:16384
    ds_read_b64_tr_b16 v[202:203], v104 offset:18432
    ds_read_b64_tr_b16 v[204:205], v28 offset:24576
    ds_read_b64_tr_b16 v[206:207], v104 offset:26624
    s_barrier
    ds_read_b64_tr_b16 v[208:209], v29 offset:0
    ds_read_b64_tr_b16 v[210:211], v105 offset:2048
    ds_read_b64_tr_b16 v[212:213], v29 offset:8192
    ds_read_b64_tr_b16 v[214:215], v105 offset:10240
    ds_read_b64_tr_b16 v[216:217], v29 offset:16384
    ds_read_b64_tr_b16 v[218:219], v105 offset:18432
    ds_read_b64_tr_b16 v[220:221], v29 offset:24576
    ds_read_b64_tr_b16 v[222:223], v105 offset:26624
    ds_read_b64_tr_b16 v[224:225], v30 offset:0
    ds_read_b64_tr_b16 v[226:227], v106 offset:2048
    ds_read_b64_tr_b16 v[228:229], v30 offset:8192
    ds_read_b64_tr_b16 v[230:231], v106 offset:10240
    ds_read_b64_tr_b16 v[232:233], v30 offset:16384
    ds_read_b64_tr_b16 v[234:235], v106 offset:18432
    ds_read_b64_tr_b16 v[236:237], v30 offset:24576
    ds_read_b64_tr_b16 v[238:239], v106 offset:26624
    ds_read_b64_tr_b16 v[240:241], v31 offset:0
    ds_read_b64_tr_b16 v[242:243], v107 offset:2048
    ds_read_b64_tr_b16 v[244:245], v31 offset:8192
    ds_read_b64_tr_b16 v[246:247], v107 offset:10240
    ds_read_b64_tr_b16 v[248:249], v31 offset:16384
    ds_read_b64_tr_b16 v[250:251], v107 offset:18432
    ds_read_b64_tr_b16 v[252:253], v31 offset:24576
    ds_read_b64_tr_b16 v[254:255], v107 offset:26624
    s_setprio 0
    s_waitcnt lgkmcnt(0)
    s_barrier
    ds_read_b128 v[32:35], v98 offset:0
    ds_read_b128 v[36:39], v98 offset:2048
    ds_read_b128 v[40:43], v98 offset:4096
    ds_read_b128 v[44:47], v98 offset:6144
    s_waitcnt lgkmcnt(3)
    v_mfma_f32_16x16x32_bf16 v[64:67], v[32:35], v[128:131], 0
    s_waitcnt lgkmcnt(2)
    v_mfma_f32_16x16x32_bf16 v[64:67], v[36:39], v[132:135], v[64:67]
    s_waitcnt lgkmcnt(1)
    v_mfma_f32_16x16x32_bf16 v[64:67], v[40:43], v[136:139], v[64:67]
    s_waitcnt lgkmcnt(0)
    v_mfma_f32_16x16x32_bf16 v[64:67], v[44:47], v[140:143], v[64:67]
    ds_read_b128 v[48:51], v98 offset:256
    v_mfma_f32_16x16x32_bf16 v[68:71], v[32:35], v[144:147], 0
    ds_read_b128 v[52:55], v98 offset:2304
    v_mfma_f32_16x16x32_bf16 v[68:71], v[36:39], v[148:151], v[68:71]
    ds_read_b128 v[56:59], v98 offset:4352
    v_mfma_f32_16x16x32_bf16 v[68:71], v[40:43], v[152:155], v[68:71]
    ds_read_b128 v[60:63], v98 offset:6400
    v_mfma_f32_16x16x32_bf16 v[68:71], v[44:47], v[156:159], v[68:71]
    v_mfma_f32_16x16x32_bf16 v[72:75], v[32:35], v[160:163], 0
    s_barrier
    v_mfma_f32_16x16x32_bf16 v[72:75], v[36:39], v[164:167], v[72:75]
    v_mfma_f32_16x16x32_bf16 v[72:75], v[40:43], v[168:171], v[72:75]
    s_nop 3
    v_cvt_pk_bf16_f32 v8, v64, v68
    v_bfi_b32 v8, v6, s24, v8
    v_mfma_f32_16x16x32_bf16 v[72:75], v[44:47], v[172:175], v[72:75]
    v_cvt_pk_bf16_f32 v12, v65, v69
    v_bfi_b32 v12, v6, s24, v12
    v_mfma_f32_16x16x32_bf16 v[76:79], v[32:35], v[176:179], 0
    v_cvt_pk_bf16_f32 v16, v66, v70
    v_bfi_b32 v16, v6, s24, v16
    v_mfma_f32_16x16x32_bf16 v[76:79], v[36:39], v[180:183], v[76:79]
    v_cvt_pk_bf16_f32 v20, v67, v71
    v_bfi_b32 v20, v6, s24, v20
    v_mfma_f32_16x16x32_bf16 v[76:79], v[40:43], v[184:187], v[76:79]
    v_mfma_f32_16x16x32_bf16 v[76:79], v[44:47], v[188:191], v[76:79]
    v_mfma_f32_16x16x32_bf16 v[80:83], v[32:35], v[192:195], 0
    v_mfma_f32_16x16x32_bf16 v[80:83], v[36:39], v[196:199], v[80:83]
    v_mfma_f32_16x16x32_bf16 v[80:83], v[40:43], v[200:203], v[80:83]
    s_nop 4
    v_cvt_pk_bf16_f32 v9, v72, v76
    v_bfi_b32 v9, v6, s25, v9
    v_mfma_f32_16x16x32_bf16 v[80:83], v[44:47], v[204:207], v[80:83]
    v_cvt_pk_bf16_f32 v13, v73, v77
    v_bfi_b32 v13, v6, s25, v13
    v_mfma_f32_16x16x32_bf16 v[84:87], v[32:35], v[208:211], 0
    v_cvt_pk_bf16_f32 v17, v74, v78
    v_bfi_b32 v17, v6, s25, v17
    v_mfma_f32_16x16x32_bf16 v[84:87], v[36:39], v[212:215], v[84:87]
    v_cvt_pk_bf16_f32 v21, v75, v79
    v_bfi_b32 v21, v6, s25, v21
    v_mfma_f32_16x16x32_bf16 v[84:87], v[40:43], v[216:219], v[84:87]
    v_mfma_f32_16x16x32_bf16 v[84:87], v[44:47], v[220:223], v[84:87]
    v_mfma_f32_16x16x32_bf16 v[88:91], v[32:35], v[224:227], 0
    v_mfma_f32_16x16x32_bf16 v[88:91], v[36:39], v[228:231], v[88:91]
    v_mfma_f32_16x16x32_bf16 v[88:91], v[40:43], v[232:235], v[88:91]
    s_nop 4
    v_cvt_pk_bf16_f32 v10, v80, v84
    v_bfi_b32 v10, v6, s26, v10
    v_mfma_f32_16x16x32_bf16 v[88:91], v[44:47], v[236:239], v[88:91]
    v_cvt_pk_bf16_f32 v14, v81, v85
    v_bfi_b32 v14, v6, s26, v14
    v_mfma_f32_16x16x32_bf16 v[92:95], v[32:35], v[240:243], 0
    v_cvt_pk_bf16_f32 v18, v82, v86
    v_bfi_b32 v18, v6, s26, v18
    v_mfma_f32_16x16x32_bf16 v[92:95], v[36:39], v[244:247], v[92:95]
    v_cvt_pk_bf16_f32 v22, v83, v87
    v_bfi_b32 v22, v6, s26, v22
    v_mfma_f32_16x16x32_bf16 v[92:95], v[40:43], v[248:251], v[92:95]
    v_mfma_f32_16x16x32_bf16 v[92:95], v[44:47], v[252:255], v[92:95]
    s_waitcnt lgkmcnt(3)
    v_mfma_f32_16x16x32_bf16 v[96:99], v[48:51], v[128:131], 0
    s_waitcnt lgkmcnt(2)
    v_mfma_f32_16x16x32_bf16 v[96:99], v[52:55], v[132:135], v[96:99]
    s_waitcnt lgkmcnt(1)
    v_mfma_f32_16x16x32_bf16 v[96:99], v[56:59], v[136:139], v[96:99]
    s_nop 1
    v_cvt_pk_bf16_f32 v11, v88, v92
    v_bfi_b32 v11, v6, s27, v11
    s_waitcnt lgkmcnt(0)
    v_mfma_f32_16x16x32_bf16 v[96:99], v[60:63], v[140:143], v[96:99]
    buffer_store_dwordx4 v[8:11], v1, s[56:59], s64 offen sc1
    v_mfma_f32_16x16x32_bf16 v[100:103], v[48:51], v[144:147], 0
    v_mfma_f32_16x16x32_bf16 v[100:103], v[52:55], v[148:151], v[100:103]
    v_mfma_f32_16x16x32_bf16 v[100:103], v[56:59], v[152:155], v[100:103]
    v_cvt_pk_bf16_f32 v15, v89, v93
    v_bfi_b32 v15, v6, s27, v15
    v_mfma_f32_16x16x32_bf16 v[100:103], v[60:63], v[156:159], v[100:103]
    buffer_store_dwordx4 v[12:15], v1, s[56:59], s65 offen sc1
    v_mfma_f32_16x16x32_bf16 v[104:107], v[48:51], v[160:163], 0
    v_mfma_f32_16x16x32_bf16 v[104:107], v[52:55], v[164:167], v[104:107]
    v_mfma_f32_16x16x32_bf16 v[104:107], v[56:59], v[168:171], v[104:107]
    v_cvt_pk_bf16_f32 v19, v90, v94
    v_bfi_b32 v19, v6, s27, v19
    v_mfma_f32_16x16x32_bf16 v[104:107], v[60:63], v[172:175], v[104:107]
    buffer_store_dwordx4 v[16:19], v1, s[56:59], s66 offen sc1
    v_cvt_pk_bf16_f32 v64, v96, v100
    v_bfi_b32 v64, v6, s24, v64
    v_mfma_f32_16x16x32_bf16 v[108:111], v[48:51], v[176:179], 0
    v_cvt_pk_bf16_f32 v68, v97, v101
    v_bfi_b32 v68, v6, s24, v68
    v_mfma_f32_16x16x32_bf16 v[108:111], v[52:55], v[180:183], v[108:111]
    v_cvt_pk_bf16_f32 v72, v98, v102
    v_bfi_b32 v72, v6, s24, v72
    v_mfma_f32_16x16x32_bf16 v[108:111], v[56:59], v[184:187], v[108:111]
    v_cvt_pk_bf16_f32 v23, v91, v95
    v_bfi_b32 v23, v6, s27, v23
    v_mfma_f32_16x16x32_bf16 v[108:111], v[60:63], v[188:191], v[108:111]
    buffer_store_dwordx4 v[20:23], v1, s[56:59], s67 offen sc1
    v_cvt_pk_bf16_f32 v76, v99, v103
    v_bfi_b32 v76, v6, s24, v76
    v_mfma_f32_16x16x32_bf16 v[112:115], v[48:51], v[192:195], 0
    v_mfma_f32_16x16x32_bf16 v[112:115], v[52:55], v[196:199], v[112:115]
    v_mfma_f32_16x16x32_bf16 v[112:115], v[56:59], v[200:203], v[112:115]
    s_nop 1
    v_cvt_pk_bf16_f32 v65, v104, v108
    v_bfi_b32 v65, v6, s25, v65
    v_mfma_f32_16x16x32_bf16 v[112:115], v[60:63], v[204:207], v[112:115]
    v_cvt_pk_bf16_f32 v69, v105, v109
    v_bfi_b32 v69, v6, s25, v69
    v_mfma_f32_16x16x32_bf16 v[116:119], v[48:51], v[208:211], 0
    v_cvt_pk_bf16_f32 v73, v106, v110
    v_bfi_b32 v73, v6, s25, v73
    v_mfma_f32_16x16x32_bf16 v[116:119], v[52:55], v[212:215], v[116:119]
    v_cvt_pk_bf16_f32 v77, v107, v111
    v_bfi_b32 v77, v6, s25, v77
    v_mfma_f32_16x16x32_bf16 v[116:119], v[56:59], v[216:219], v[116:119]
    v_mfma_f32_16x16x32_bf16 v[116:119], v[60:63], v[220:223], v[116:119]
    v_mfma_f32_16x16x32_bf16 v[120:123], v[48:51], v[224:227], 0
    v_mfma_f32_16x16x32_bf16 v[120:123], v[52:55], v[228:231], v[120:123]
    v_mfma_f32_16x16x32_bf16 v[120:123], v[56:59], v[232:235], v[120:123]
    s_nop 4
    v_cvt_pk_bf16_f32 v66, v112, v116
    v_bfi_b32 v66, v6, s26, v66
    v_mfma_f32_16x16x32_bf16 v[120:123], v[60:63], v[236:239], v[120:123]
    v_cvt_pk_bf16_f32 v70, v113, v117
    v_bfi_b32 v70, v6, s26, v70
    v_mfma_f32_16x16x32_bf16 v[124:127], v[48:51], v[240:243], 0
    v_cvt_pk_bf16_f32 v74, v114, v118
    v_bfi_b32 v74, v6, s26, v74
    v_mfma_f32_16x16x32_bf16 v[124:127], v[52:55], v[244:247], v[124:127]
    v_cvt_pk_bf16_f32 v78, v115, v119
    v_bfi_b32 v78, v6, s26, v78
    v_mfma_f32_16x16x32_bf16 v[124:127], v[56:59], v[248:251], v[124:127]
    v_mfma_f32_16x16x32_bf16 v[124:127], v[60:63], v[252:255], v[124:127]
    s_nop 7
    v_cvt_pk_bf16_f32 v67, v120, v124
    v_bfi_b32 v67, v6, s27, v67
    buffer_store_dwordx4 v[64:67], v1, s[56:59], s68 offen sc1
    v_cvt_pk_bf16_f32 v71, v121, v125
    v_bfi_b32 v71, v6, s27, v71
    buffer_store_dwordx4 v[68:71], v1, s[56:59], s69 offen sc1
    v_cvt_pk_bf16_f32 v75, v122, v126
    v_bfi_b32 v75, v6, s27, v75
    buffer_store_dwordx4 v[72:75], v1, s[56:59], s70 offen sc1
    v_cvt_pk_bf16_f32 v79, v123, v127
    v_bfi_b32 v79, v6, s27, v79
    buffer_store_dwordx4 v[76:79], v1, s[56:59], s71 offen sc1
    s_branch L_exit
L_S1:
    s_load_dwordx2 s[60:61], s[0:1], 32
    s_load_dwordx2 s[40:41], s[0:1], 56
    s_load_dwordx2 s[48:49], s[0:1], 72
    s_load_dwordx2 s[52:53], s[0:1], 64
    s_mov_b32 s42, 1835008
    s_mov_b32 s43, 0x20000
    s_mov_b32 s50, 1835008
    s_mov_b32 s51, 0x20000
    s_mov_b32 s54, 3584
    s_mov_b32 s55, 0x20000
    s_mov_b32 s62, 4194304
    s_mov_b32 s63, 0x20000
    v_lshlrev_b32 v5, 17, v3
    v_lshlrev_b32 v6, 2, v3
    v_xor_b32 v6, v6, v2
    v_lshl_add_u32 v4, v6, 4, v5
    v_xor_b32 v26, 32, v4
    s_lshl_b32 s10, s8, 5
    s_add_u32 s10, s10, s3
    s_lshl_b32 s10, s10, 15
    s_lshl_b32 s11, s7, 8
    s_add_u32 s10, s10, s11
    s_lshl_b32 s11, s3, 13
    s_add_u32 s11, s11, 131072
    v_bfe_u32 v6, v0, 2, 2
    v_bfe_u32 v7, v0, 4, 1
    v_bfe_u32 v5, v0, 1, 1
    v_lshl_or_b32 v7, v7, 1, v5
    v_lshl_or_b32 v7, v6, 2, v7
    s_lshl_b32 s12, s3, 2
    v_xor_b32 v7, s12, v7
    v_lshlrev_b32 v7, 4, v7
    v_lshlrev_b32 v6, 8, v6
    v_lshl_add_u32 v6, v3, 11, v6
    v_and_b32 v5, 1, v0
    v_lshl_add_u32 v6, v5, 3, v6
    v_add_u32 v6, 131072, v6
    v_add_u32 v8, v6, v7
    v_xor_b32 v9, 32, v8
    v_and_b32 v5, 7, v0
    v_lshl_add_u32 v5, v5, 2, v3
    v_lshlrev_b32 v10, 9, v5
    v_lshlrev_b32 v11, 4, v0
    v_lshlrev_b32 v5, 4, v2
    v_lshl_add_u32 v5, v3, 3, v5
    s_lshl_b32 s12, s3, 6
    s_add_u32 s13, s12, s11
    v_add_u32 v12, s13, v5
    v_and_b32 v5, 3, v0
    v_mul_u32_u24 v5, 8256, v5
    v_lshl_add_u32 v5, v3, 4, v5
    v_add_u32 v13, 131072, v5
    v_bfe_u32 v5, v0, 4, 1
    v_bfe_u32 v6, v0, 1, 1
    v_lshl_or_b32 v5, v5, 1, v6
    v_bfe_u32 v6, v0, 2, 2
    v_lshl_or_b32 v5, v5, 2, v6
    v_and_b32 v6, 1, v0
    v_lshl_or_b32 v5, v5, 1, v6
    s_add_u32 s13, s12, 133120
    v_lshl_add_u32 v14, v5, 1, s13
    v_mov_b32 v15, s11
    v_mov_b32 v31, 131072
    v_mov_b32 v30, 0x10001
    v_bfe_u32 v5, v0, 4, 1
    v_cmp_eq_u32 s[18:19], 1, v5
    s_mov_b32 m0, s11
    s_nop 0
    s_lshl2_add_u32 s15, s8, s3
    s_mul_i32 s15, s15, 114688
    s_lshr_b32 s16, s5, 2
    s_sub_u32 s9, s4, 1
    s_lshl2_add_u32 s16, s9, s16
    s_lshl_b32 s16, s16, 7
    s_add_u32 s15, s15, s16
    v_mul_u32_u24 v20, 3584, v0
    s_lshl4_add_u32 s9, s9, s5
    s_waitcnt lgkmcnt(0)
    s_barrier
    v_mov_b32 v96, 0
    v_mov_b32 v97, 0
    v_mov_b32 v98, 0
    v_mov_b32 v99, 0
    v_mov_b32 v100, 0
    v_mov_b32 v101, 0
    v_mov_b32 v102, 0
    v_mov_b32 v103, 0
    v_mov_b32 v104, 0
    v_mov_b32 v105, 0
    v_mov_b32 v106, 0
    v_mov_b32 v107, 0
    v_mov_b32 v108, 0
    v_mov_b32 v109, 0
    v_mov_b32 v110, 0
    v_mov_b32 v111, 0
    s_cmp_eq_u32 s4, 0
    s_cbranch_scc1 L_nomlp
    s_mov_b32 exec_hi, 0
    buffer_load_dword v239, v20, s[40:43], s15 offen
    s_mov_b64 exec, -1
    s_cmp_lg_u32 s3, 3
    s_cbranch_scc1 L_nomlp
    s_lshl_b32 s15, s9, 5
    s_lshl_b32 s16, s9, 14
    v_lshlrev_b32 v21, 12, v3
    v_lshl_add_u32 v21, v2, 4, v21
    v_lshlrev_b32 v22, 1, v2
    buffer_load_ushort v48, v22, s[52:55], s15 offen
    v_mov_b32 v27, v21
    v_lshrrev_b32 v20, 1, v0
    v_mul_u32_u24 v20, 3584, v20
    v_and_b32 v21, 1, v0
    v_lshl_add_u32 v20, v21, 4, v20
    v_lshlrev_b32 v21, 4, v0
    v_add_u32 v21, 131072, v21
    ds_write_b128 v21, v[56:59]
    v_lshlrev_b32 v21, 4, v3
    v_add_u32 v21, 131072, v21
    v_lshlrev_b32 v22, 8, v3
    v_lshl_add_u32 v22, v2, 3, v22
    v_add_u32 v22, 147456, v22
    v_lshl_add_u32 v23, v3, 2, v2
    v_and_b32 v23, 15, v23
    v_lshlrev_b32 v23, 2, v23
    s_mov_b32 m0, 147456
    ds_read_b128 v[64:67], v21 offset:0
    ds_read_b128 v[68:71], v21 offset:64
    ds_read_b128 v[72:75], v21 offset:128
    ds_read_b128 v[76:79], v21 offset:192
    ds_read_b128 v[80:83], v21 offset:256
    ds_read_b128 v[84:87], v21 offset:320
    ds_read_b128 v[88:91], v21 offset:384
    ds_read_b128 v[92:95], v21 offset:448
    ds_read_b128 v[96:99], v21 offset:512
    ds_read_b128 v[100:103], v21 offset:576
    ds_read_b128 v[104:107], v21 offset:640
    ds_read_b128 v[108:111], v21 offset:704
    ds_read_b128 v[112:115], v21 offset:768
    ds_read_b128 v[116:119], v21 offset:832
    ds_read_b128 v[120:123], v21 offset:896
    ds_read_b128 v[124:127], v21 offset:960
    s_waitcnt vmcnt(0)
    buffer_load_dwordx4 v20, s[40:43], s15 offen lds
    s_addk_i32 m0, 0x400
    s_add_u32 s15, s15, 114688
    buffer_load_dwordx4 v20, s[40:43], s15 offen lds
    s_addk_i32 m0, 0x400
    s_add_u32 s15, s15, 114688
    buffer_load_dwordx4 v20, s[40:43], s15 offen lds
    s_addk_i32 m0, 0x400
    s_add_u32 s15, s15, 114688
    buffer_load_dwordx4 v20, s[40:43], s15 offen lds
    s_addk_i32 m0, 0x400
    s_add_u32 s15, s15, 114688
    buffer_load_dwordx4 v20, s[40:43], s15 offen lds
    s_addk_i32 m0, 0x400
    s_add_u32 s15, s15, 114688
    buffer_load_dwordx4 v20, s[40:43], s15 offen lds
    s_addk_i32 m0, 0x400
    s_add_u32 s15, s15, 114688
    buffer_load_dwordx4 v20, s[40:43], s15 offen lds
    s_addk_i32 m0, 0x400
    s_add_u32 s15, s15, 114688
    buffer_load_dwordx4 v20, s[40:43], s15 offen lds
    s_addk_i32 m0, 0x400
    s_add_u32 s15, s15, 114688
    buffer_load_dwordx4 v20, s[40:43], s15 offen lds
    s_addk_i32 m0, 0x400
    s_add_u32 s15, s15, 114688
    buffer_load_dwordx4 v20, s[40:43], s15 offen lds
    s_addk_i32 m0, 0x400
    s_add_u32 s15, s15, 114688
    buffer_load_dwordx4 v20, s[40:43], s15 offen lds
    s_addk_i32 m0, 0x400
    s_add_u32 s15, s15, 114688
    buffer_load_dwordx4 v20, s[40:43], s15 offen lds
    s_addk_i32 m0, 0x400
    s_add_u32 s15, s15, 114688
    buffer_load_dwordx4 v20, s[40:43], s15 offen lds
    s_addk_i32 m0, 0x400
    s_add_u32 s15, s15, 114688
    buffer_load_dwordx4 v20, s[40:43], s15 offen lds
    s_addk_i32 m0, 0x400
    s_add_u32 s15, s15, 114688
    buffer_load_dwordx4 v20, s[40:43], s15 offen lds
    s_addk_i32 m0, 0x400
    s_add_u32 s15, s15, 114688
    buffer_load_dwordx4 v20, s[40:43], s15 offen lds
    s_waitcnt vmcnt(8)
    s_barrier
    buffer_load_dwordx4 v[192:195], v27, s[48:51], s16 offen offset:0 nt
    buffer_load_dwordx4 v[196:199], v27, s[48:51], s16 offen offset:256 nt
    buffer_load_dwordx4 v[200:203], v27, s[48:51], s16 offen offset:512 nt
    buffer_load_dwordx4 v[204:207], v27, s[48:51], s16 offen offset:768 nt
    buffer_load_dwordx4 v[208:211], v27, s[48:51], s16 offen offset:1024 nt
    buffer_load_dwordx4 v[212:215], v27, s[48:51], s16 offen offset:1280 nt
    buffer_load_dwordx4 v[216:219], v27, s[48:51], s16 offen offset:1536 nt
    buffer_load_dwordx4 v[220:223], v27, s[48:51], s16 offen offset:1792 nt
    buffer_load_dwordx4 v[224:227], v27, s[48:51], s16 offen offset:2048 nt
    buffer_load_dwordx4 v[228:231], v27, s[48:51], s16 offen offset:2304 nt
    buffer_load_dwordx4 v[232:235], v27, s[48:51], s16 offen offset:2560 nt
    buffer_load_dwordx4 v[236:239], v27, s[48:51], s16 offen offset:2816 nt
    buffer_load_dwordx4 v[240:243], v27, s[48:51], s16 offen offset:3072 nt
    buffer_load_dwordx4 v[244:247], v27, s[48:51], s16 offen offset:3328 nt
    buffer_load_dwordx4 v[248:251], v27, s[48:51], s16 offen offset:3584 nt
    buffer_load_dwordx4 v[252:255], v27, s[48:51], s16 offen offset:3840 nt
    s_waitcnt vmcnt(16)
    ds_read_b64_tr_b16 v[128:129], v22 offset:0
    ds_read_b64_tr_b16 v[130:131], v22 offset:128
    ds_read_b64_tr_b16 v[132:133], v22 offset:1024
    ds_read_b64_tr_b16 v[134:135], v22 offset:1152
    ds_read_b64_tr_b16 v[136:137], v22 offset:2048
    ds_read_b64_tr_b16 v[138:139], v22 offset:2176
    ds_read_b64_tr_b16 v[140:141], v22 offset:3072
    ds_read_b64_tr_b16 v[142:143], v22 offset:3200
    ds_read_b64_tr_b16 v[144:145], v22 offset:4096
    ds_read_b64_tr_b16 v[146:147], v22 offset:4224
    ds_read_b64_tr_b16 v[148:149], v22 offset:5120
    ds_read_b64_tr_b16 v[150:151], v22 offset:5248
    ds_read_b64_tr_b16 v[152:153], v22 offset:6144
    ds_read_b64_tr_b16 v[154:155], v22 offset:6272
    ds_read_b64_tr_b16 v[156:157], v22 offset:7168
    ds_read_b64_tr_b16 v[158:159], v22 offset:7296
    ds_read_b64_tr_b16 v[160:161], v22 offset:8192
    ds_read_b64_tr_b16 v[162:163], v22 offset:8320
    ds_read_b64_tr_b16 v[164:165], v22 offset:9216
    ds_read_b64_tr_b16 v[166:167], v22 offset:9344
    ds_read_b64_tr_b16 v[168:169], v22 offset:10240
    ds_read_b64_tr_b16 v[170:171], v22 offset:10368
    ds_read_b64_tr_b16 v[172:173], v22 offset:11264
    ds_read_b64_tr_b16 v[174:175], v22 offset:11392
    ds_read_b64_tr_b16 v[176:177], v22 offset:12288
    ds_read_b64_tr_b16 v[178:179], v22 offset:12416
    ds_read_b64_tr_b16 v[180:181], v22 offset:13312
    ds_read_b64_tr_b16 v[182:183], v22 offset:13440
    ds_read_b64_tr_b16 v[184:185], v22 offset:14336
    ds_read_b64_tr_b16 v[186:187], v22 offset:14464
    ds_read_b64_tr_b16 v[188:189], v22 offset:15360
    ds_read_b64_tr_b16 v[190:191], v22 offset:15488
    s_waitcnt lgkmcnt(0)
    v_mfma_f32_16x16x32_bf16 v[16:19], v[64:67], v[128:131], 0
    v_mfma_f32_16x16x32_bf16 v[16:19], v[68:71], v[132:135], v[16:19]
    v_mfma_f32_16x16x32_bf16 v[16:19], v[72:75], v[136:139], v[16:19]
    v_mfma_f32_16x16x32_bf16 v[16:19], v[76:79], v[140:143], v[16:19]
    v_mfma_f32_16x16x32_bf16 v[16:19], v[80:83], v[144:147], v[16:19]
    v_mfma_f32_16x16x32_bf16 v[16:19], v[84:87], v[148:151], v[16:19]
    v_mfma_f32_16x16x32_bf16 v[16:19], v[88:91], v[152:155], v[16:19]
    v_mfma_f32_16x16x32_bf16 v[16:19], v[92:95], v[156:159], v[16:19]
    v_mfma_f32_16x16x32_bf16 v[16:19], v[96:99], v[160:163], v[16:19]
    v_mfma_f32_16x16x32_bf16 v[16:19], v[100:103], v[164:167], v[16:19]
    v_mfma_f32_16x16x32_bf16 v[16:19], v[104:107], v[168:171], v[16:19]
    v_mfma_f32_16x16x32_bf16 v[16:19], v[108:111], v[172:175], v[16:19]
    v_mfma_f32_16x16x32_bf16 v[16:19], v[112:115], v[176:179], v[16:19]
    v_mfma_f32_16x16x32_bf16 v[16:19], v[116:119], v[180:183], v[16:19]
    v_mfma_f32_16x16x32_bf16 v[16:19], v[120:123], v[184:187], v[16:19]
    v_mfma_f32_16x16x32_bf16 v[16:19], v[124:127], v[188:191], v[16:19]
    s_nop 7
    v_cvt_pk_bf16_f32 v20, v16, v16
    v_and_b32 v20, 0xffff0000, v20
    v_lshlrev_b32 v48, 16, v48
    v_add_f32 v20, v20, v48
    v_cvt_pk_bf16_f32 v20, v20, v20
    v_and_b32 v20, 0xffff0000, v20
    v_max_f32 v20, 0, v20
    v_mul_f32 v20, v20, v20
    v_cvt_pk_bf16_f32 v20, v20, v20
    ds_bpermute_b32 v21, v23, v20
    s_waitcnt lgkmcnt(0)
    v_and_b32_dpp v64, v21, v32 row_newbcast:0 row_mask:0xf bank_mask:0xf
    v_and_b32_dpp v65, v21, v33 row_newbcast:0 row_mask:0xf bank_mask:0xf
    v_and_b32_dpp v66, v21, v34 row_newbcast:0 row_mask:0xf bank_mask:0xf
    v_and_b32_dpp v67, v21, v35 row_newbcast:0 row_mask:0xf bank_mask:0xf
    v_and_b32_dpp v68, v21, v32 row_newbcast:1 row_mask:0xf bank_mask:0xf
    v_and_b32_dpp v69, v21, v33 row_newbcast:1 row_mask:0xf bank_mask:0xf
    v_and_b32_dpp v70, v21, v34 row_newbcast:1 row_mask:0xf bank_mask:0xf
    v_and_b32_dpp v71, v21, v35 row_newbcast:1 row_mask:0xf bank_mask:0xf
    v_and_b32_dpp v72, v21, v32 row_newbcast:2 row_mask:0xf bank_mask:0xf
    v_and_b32_dpp v73, v21, v33 row_newbcast:2 row_mask:0xf bank_mask:0xf
    v_and_b32_dpp v74, v21, v34 row_newbcast:2 row_mask:0xf bank_mask:0xf
    v_and_b32_dpp v75, v21, v35 row_newbcast:2 row_mask:0xf bank_mask:0xf
    v_and_b32_dpp v76, v21, v32 row_newbcast:3 row_mask:0xf bank_mask:0xf
    v_and_b32_dpp v77, v21, v33 row_newbcast:3 row_mask:0xf bank_mask:0xf
    v_and_b32_dpp v78, v21, v34 row_newbcast:3 row_mask:0xf bank_mask:0xf
    v_and_b32_dpp v79, v21, v35 row_newbcast:3 row_mask:0xf bank_mask:0xf
    s_mov_b32 m0, s11
    s_barrier
    buffer_load_dwordx4 v4, s[60:63], s10 offen nt lds
    s_add_u32 m0, m0, 1024
    s_add_u32 s10, s10, 524288
    buffer_load_dwordx4 v4, s[60:63], s10 offen nt lds
    s_add_u32 m0, m0, 1024
    s_add_u32 s10, s10, 4294451200
    buffer_load_dwordx4 v26, s[60:63], s10 offen nt lds
    s_add_u32 m0, m0, 1024
    s_add_u32 s10, s10, 524288
    buffer_load_dwordx4 v26, s[60:63], s10 offen nt lds
    s_add_u32 m0, m0, 1024
    s_add_u32 s10, s10, 4294451200
    buffer_load_dwordx4 v4, s[60:63], s10 offen nt lds
    s_add_u32 m0, m0, 1024
    s_add_u32 s10, s10, 524288
    buffer_load_dwordx4 v4, s[60:63], s10 offen nt lds
    s_add_u32 m0, m0, 1024
    s_add_u32 s10, s10, 4294451200
    buffer_load_dwordx4 v26, s[60:63], s10 offen nt lds
    s_add_u32 m0, m0, 1024
    s_add_u32 s10, s10, 524288
    buffer_load_dwordx4 v26, s[60:63], s10 offen nt lds
    s_waitcnt vmcnt(8)
    v_mfma_f32_16x16x32_bf16 v[96:99], v[64:67], v[192:195], 0
    v_mfma_f32_16x16x32_bf16 v[100:103], v[64:67], v[196:199], 0
    v_mfma_f32_16x16x32_bf16 v[104:107], v[64:67], v[200:203], 0
    v_mfma_f32_16x16x32_bf16 v[108:111], v[64:67], v[204:207], 0
    v_mfma_f32_16x16x32_bf16 v[96:99], v[68:71], v[208:211], v[96:99]
    v_mfma_f32_16x16x32_bf16 v[100:103], v[68:71], v[212:215], v[100:103]
    v_mfma_f32_16x16x32_bf16 v[104:107], v[68:71], v[216:219], v[104:107]
    v_mfma_f32_16x16x32_bf16 v[108:111], v[68:71], v[220:223], v[108:111]
    v_mfma_f32_16x16x32_bf16 v[96:99], v[72:75], v[224:227], v[96:99]
    v_mfma_f32_16x16x32_bf16 v[100:103], v[72:75], v[228:231], v[100:103]
    v_mfma_f32_16x16x32_bf16 v[104:107], v[72:75], v[232:235], v[104:107]
    v_mfma_f32_16x16x32_bf16 v[108:111], v[72:75], v[236:239], v[108:111]
    v_mfma_f32_16x16x32_bf16 v[96:99], v[76:79], v[240:243], v[96:99]
    v_mfma_f32_16x16x32_bf16 v[100:103], v[76:79], v[244:247], v[100:103]
    v_mfma_f32_16x16x32_bf16 v[104:107], v[76:79], v[248:251], v[104:107]
    v_mfma_f32_16x16x32_bf16 v[108:111], v[76:79], v[252:255], v[108:111]
    s_nop 7
    s_branch L_wuv_done
L_nomlp:
    s_barrier
    s_mov_b32 m0, s11
    s_barrier
    buffer_load_dwordx4 v4, s[60:63], s10 offen nt lds
    s_add_u32 m0, m0, 1024
    s_add_u32 s10, s10, 524288
    buffer_load_dwordx4 v4, s[60:63], s10 offen nt lds
    s_add_u32 m0, m0, 1024
    s_add_u32 s10, s10, 4294451200
    buffer_load_dwordx4 v26, s[60:63], s10 offen nt lds
    s_add_u32 m0, m0, 1024
    s_add_u32 s10, s10, 524288
    buffer_load_dwordx4 v26, s[60:63], s10 offen nt lds
    s_add_u32 m0, m0, 1024
    s_add_u32 s10, s10, 4294451200
    buffer_load_dwordx4 v4, s[60:63], s10 offen nt lds
    s_add_u32 m0, m0, 1024
    s_add_u32 s10, s10, 524288
    buffer_load_dwordx4 v4, s[60:63], s10 offen nt lds
    s_add_u32 m0, m0, 1024
    s_add_u32 s10, s10, 4294451200
    buffer_load_dwordx4 v26, s[60:63], s10 offen nt lds
    s_add_u32 m0, m0, 1024
    s_add_u32 s10, s10, 524288
    buffer_load_dwordx4 v26, s[60:63], s10 offen nt lds
L_wuv_done:
    s_lshl_b32 s12, s3, 13
    s_lshl2_add_u32 s16, s7, s8
    s_lshl_b32 s13, s16, 15
    s_add_u32 s13, s13, s12
    s_add_u32 s13, s13, 1048576
    s_lshl_b32 s12, s12, 1
    s_lshl4_add_u32 s12, s7, s12
    s_add_u32 s12, s12, 327680
    s_waitcnt vmcnt(0)
    s_add_u32 s36, s56, s13
    s_addc_u32 s37, s57, 0
    s_load_dwordx2 s[64:65], s[36:37], 896 glc
    s_load_dwordx2 s[66:67], s[36:37], 2944 glc
    s_load_dwordx2 s[68:69], s[36:37], 4992 glc
    s_load_dwordx2 s[70:71], s[36:37], 7040 glc
    s_barrier
    ds_read_b64_tr_b16 v[160:161], v8 offset:0
    ds_read_b64_tr_b16 v[162:163], v8 offset:1024
    ds_read_b64_tr_b16 v[164:165], v8 offset:8192
    ds_read_b64_tr_b16 v[166:167], v8 offset:9216
    ds_read_b64_tr_b16 v[168:169], v8 offset:16384
    ds_read_b64_tr_b16 v[170:171], v8 offset:17408
    ds_read_b64_tr_b16 v[172:173], v8 offset:24576
    ds_read_b64_tr_b16 v[174:175], v8 offset:25600
    ds_read_b64_tr_b16 v[176:177], v9 offset:0
    ds_read_b64_tr_b16 v[178:179], v9 offset:1024
    ds_read_b64_tr_b16 v[180:181], v9 offset:8192
    ds_read_b64_tr_b16 v[182:183], v9 offset:9216
    ds_read_b64_tr_b16 v[184:185], v9 offset:16384
    ds_read_b64_tr_b16 v[186:187], v9 offset:17408
    ds_read_b64_tr_b16 v[188:189], v9 offset:24576
    ds_read_b64_tr_b16 v[190:191], v9 offset:25600
    s_waitcnt lgkmcnt(0)
    s_barrier
    s_cmp_lg_u32 s3, 3
    s_cbranch_scc1 L_nomw
    v_add_u32 v20, 135168, v41
    s_mov_b32 exec_hi, 0
    ds_write_b128 v20, v[96:99] offset:0
    ds_write_b128 v20, v[100:103] offset:512
    ds_write_b128 v20, v[104:107] offset:1024
    ds_write_b128 v20, v[108:111] offset:1536
    s_mov_b64 exec, -1
L_nomw:
    s_xor_b32 s38, s25, 0x10001
    s_xor_b32 s39, s27, 0x10001
    s_branch L_bhint0_chk
L_bhint0:
    s_load_dwordx2 s[64:65], s[36:37], 896 glc
    s_load_dwordx2 s[66:67], s[36:37], 2944 glc
    s_load_dwordx2 s[68:69], s[36:37], 4992 glc
    s_load_dwordx2 s[70:71], s[36:37], 7040 glc
L_bhint0_chk:
    s_waitcnt lgkmcnt(0)
    s_xor_b64 s[64:65], s[64:65], s[24:25]
    s_xor_b64 s[66:67], s[66:67], s[24:25]
    s_or_b64 s[64:65], s[64:65], s[66:67]
    s_xor_b64 s[68:69], s[68:69], s[24:25]
    s_or_b64 s[64:65], s[64:65], s[68:69]
    s_xor_b64 s[70:71], s[70:71], s[24:25]
    s_or_b64 s[64:65], s[64:65], s[70:71]
    s_or_b32 s64, s64, s65
    s_add_u32 s28, s28, 1
    s_cmp_gt_u32 s28, 131072
    s_cbranch_scc1 L_exit
    s_and_b32 s64, s64, 0x10001
    s_cbranch_scc1 L_bhint0
    s_add_u32 s14, s13, 4096
    s_cmp_eq_u32 s28, 1
    s_cbranch_scc0 L_slow
    buffer_load_dwordx4 v[16:19], v10, s[56:59], s12 offen sc1
    buffer_load_dwordx4 v[64:67], v11, s[56:59], s13 offen offset:0 sc1
    buffer_load_dwordx4 v[68:71], v11, s[56:59], s13 offen offset:1024 sc1
    buffer_load_dwordx4 v[72:75], v11, s[56:59], s13 offen offset:2048 sc1
    buffer_load_dwordx4 v[76:79], v11, s[56:59], s13 offen offset:3072 sc1
    buffer_load_dwordx4 v[80:83], v11, s[56:59], s14 offen offset:0 sc1
    buffer_load_dwordx4 v[84:87], v11, s[56:59], s14 offen offset:1024 sc1
    buffer_load_dwordx4 v[88:91], v11, s[56:59], s14 offen offset:2048 sc1
    buffer_load_dwordx4 v[92:95], v11, s[56:59], s14 offen offset:3072 sc1
    s_waitcnt vmcnt(8)
    v_xor_b32 v17, s20, v17
    v_bitop3_b32 v17, v17, v19, s20 bitop3:0xf6
    v_cmp_ne_u32 vcc, 0, v17
    s_cbranch_vccz L_ops
L_slow:
L_stp:
    buffer_load_dwordx4 v[16:19], v10, s[56:59], s12 offen sc1
    s_waitcnt vmcnt(0)
    v_xor_b32 v17, s20, v17
    v_bitop3_b32 v17, v17, v19, s20 bitop3:0xf6
    v_cmp_ne_u32 vcc, 0, v17
    s_add_u32 s28, s28, 1
    s_cmp_gt_u32 s28, 131072
    s_cbranch_scc1 L_exit
    s_cbranch_vccnz L_stp
    buffer_load_dwordx4 v[64:67], v11, s[56:59], s13 offen offset:0 sc1
    buffer_load_dwordx4 v[68:71], v11, s[56:59], s13 offen offset:1024 sc1
    buffer_load_dwordx4 v[72:75], v11, s[56:59], s13 offen offset:2048 sc1
    buffer_load_dwordx4 v[76:79], v11, s[56:59], s13 offen offset:3072 sc1
    buffer_load_dwordx4 v[80:83], v11, s[56:59], s14 offen offset:0 sc1
    buffer_load_dwordx4 v[84:87], v11, s[56:59], s14 offen offset:1024 sc1
    buffer_load_dwordx4 v[88:91], v11, s[56:59], s14 offen offset:2048 sc1
    buffer_load_dwordx4 v[92:95], v11, s[56:59], s14 offen offset:3072 sc1
L_ops:
    v_mov_b32 v24, v16
    s_nop 1
    v_max_f32_dpp v24, v24, v24 row_ror:1 row_mask:0xf bank_mask:0xf
    s_nop 1
    v_max_f32_dpp v24, v24, v24 row_ror:2 row_mask:0xf bank_mask:0xf
    s_nop 1
    v_max_f32_dpp v24, v24, v24 row_ror:4 row_mask:0xf bank_mask:0xf
    s_nop 1
    v_max_f32_dpp v24, v24, v24 row_ror:8 row_mask:0xf bank_mask:0xf
    v_mov_b32 v20, v24
    s_nop 1
    v_permlane16_swap_b32 v20, v24
    v_max_f32 v24, v24, v20
    v_mov_b32 v20, v24
    s_nop 1
    v_permlane32_swap_b32 v20, v24
    v_max_f32 v24, v24, v20
    v_sub_f32 v16, v16, v24
    v_exp_f32 v16, v16
    s_nop 0
    v_cvt_pk_bf16_f32 v16, v16, v16
    s_nop 1
    v_and_b32_dpp v128, v16, v32 row_newbcast:0 row_mask:0xf bank_mask:0xf
    v_and_b32_dpp v129, v16, v33 row_newbcast:0 row_mask:0xf bank_mask:0xf
    v_and_b32_dpp v130, v16, v34 row_newbcast:0 row_mask:0xf bank_mask:0xf
    v_and_b32_dpp v131, v16, v35 row_newbcast:0 row_mask:0xf bank_mask:0xf
    v_and_b32_dpp v132, v16, v32 row_newbcast:1 row_mask:0xf bank_mask:0xf
    v_and_b32_dpp v133, v16, v33 row_newbcast:1 row_mask:0xf bank_mask:0xf
    v_and_b32_dpp v134, v16, v34 row_newbcast:1 row_mask:0xf bank_mask:0xf
    v_and_b32_dpp v135, v16, v35 row_newbcast:1 row_mask:0xf bank_mask:0xf
    v_and_b32_dpp v136, v16, v32 row_newbcast:2 row_mask:0xf bank_mask:0xf
    v_and_b32_dpp v137, v16, v33 row_newbcast:2 row_mask:0xf bank_mask:0xf
    v_and_b32_dpp v138, v16, v34 row_newbcast:2 row_mask:0xf bank_mask:0xf
    v_and_b32_dpp v139, v16, v35 row_newbcast:2 row_mask:0xf bank_mask:0xf
    v_and_b32_dpp v140, v16, v32 row_newbcast:3 row_mask:0xf bank_mask:0xf
    v_and_b32_dpp v141, v16, v33 row_newbcast:3 row_mask:0xf bank_mask:0xf
    v_and_b32_dpp v142, v16, v34 row_newbcast:3 row_mask:0xf bank_mask:0xf
    v_and_b32_dpp v143, v16, v35 row_newbcast:3 row_mask:0xf bank_mask:0xf
    v_and_b32_dpp v144, v16, v32 row_newbcast:4 row_mask:0xf bank_mask:0xf
    v_and_b32_dpp v145, v16, v33 row_newbcast:4 row_mask:0xf bank_mask:0xf
    v_and_b32_dpp v146, v16, v34 row_newbcast:4 row_mask:0xf bank_mask:0xf
    v_and_b32_dpp v147, v16, v35 row_newbcast:4 row_mask:0xf bank_mask:0xf
    v_and_b32_dpp v148, v16, v32 row_newbcast:5 row_mask:0xf bank_mask:0xf
    v_and_b32_dpp v149, v16, v33 row_newbcast:5 row_mask:0xf bank_mask:0xf
    v_and_b32_dpp v150, v16, v34 row_newbcast:5 row_mask:0xf bank_mask:0xf
    v_and_b32_dpp v151, v16, v35 row_newbcast:5 row_mask:0xf bank_mask:0xf
    v_and_b32_dpp v152, v16, v32 row_newbcast:6 row_mask:0xf bank_mask:0xf
    v_and_b32_dpp v153, v16, v33 row_newbcast:6 row_mask:0xf bank_mask:0xf
    v_and_b32_dpp v154, v16, v34 row_newbcast:6 row_mask:0xf bank_mask:0xf
    v_and_b32_dpp v155, v16, v35 row_newbcast:6 row_mask:0xf bank_mask:0xf
    v_and_b32_dpp v156, v16, v32 row_newbcast:7 row_mask:0xf bank_mask:0xf
    v_and_b32_dpp v157, v16, v33 row_newbcast:7 row_mask:0xf bank_mask:0xf
    v_and_b32_dpp v158, v16, v34 row_newbcast:7 row_mask:0xf bank_mask:0xf
    v_and_b32_dpp v159, v16, v35 row_newbcast:7 row_mask:0xf bank_mask:0xf
    v_and_b32 v25, 0xffff0000, v16
    v_mul_f32 v25, v25, v18
    s_nop 1
    v_add_f32_dpp v25, v25, v25 row_ror:1 row_mask:0xf bank_mask:0xf
    s_nop 1
    v_add_f32_dpp v25, v25, v25 row_ror:2 row_mask:0xf bank_mask:0xf
    s_nop 1
    v_add_f32_dpp v25, v25, v25 row_ror:4 row_mask:0xf bank_mask:0xf
    s_nop 1
    v_add_f32_dpp v25, v25, v25 row_ror:8 row_mask:0xf bank_mask:0xf
    v_mov_b32 v20, v25
    s_nop 1
    v_permlane16_swap_b32 v20, v25
    v_add_f32 v25, v25, v20
    v_mov_b32 v20, v25
    s_nop 1
    v_permlane32_swap_b32 v20, v25
    v_add_f32 v25, v25, v20
    v_mul_f32 v25, 0.5, v25
    ds_write_b64 v15, v[24:25] offset:1024
L_s1go:
    s_waitcnt vmcnt(7)
    v_xor_b32 v96, s24, v64
    v_xor_b32 v97, s38, v65
    v_xor_b32 v98, s26, v66
    v_xor_b32 v99, s39, v67
    v_bitop3_b32 v48, v96, v98, v97 bitop3:0xfd
    v_bitop3_b32 v48, v48, v48, v99 bitop3:0xfd
    v_mfma_f32_16x16x32_bf16 v[40:43], v[128:131], v[96:99], 0
    s_waitcnt vmcnt(6)
    v_xor_b32 v100, s24, v68
    v_xor_b32 v101, s38, v69
    v_xor_b32 v102, s26, v70
    v_xor_b32 v103, s39, v71
    v_bitop3_b32 v49, v100, v102, v101 bitop3:0xfd
    v_bitop3_b32 v49, v49, v49, v103 bitop3:0xfd
    v_mfma_f32_16x16x32_bf16 v[40:43], v[132:135], v[100:103], v[40:43]
    s_waitcnt vmcnt(5)
    v_xor_b32 v104, s24, v72
    v_xor_b32 v105, s38, v73
    v_xor_b32 v106, s26, v74
    v_xor_b32 v107, s39, v75
    v_bitop3_b32 v50, v104, v106, v105 bitop3:0xfd
    v_bitop3_b32 v50, v50, v50, v107 bitop3:0xfd
    v_mfma_f32_16x16x32_bf16 v[40:43], v[136:139], v[104:107], v[40:43]
    v_or3_b32 v7, v48, v49, v50
    s_waitcnt vmcnt(4)
    v_xor_b32 v108, s24, v76
    v_xor_b32 v109, s38, v77
    v_xor_b32 v110, s26, v78
    v_xor_b32 v111, s39, v79
    v_bitop3_b32 v51, v108, v110, v109 bitop3:0xfd
    v_bitop3_b32 v51, v51, v51, v111 bitop3:0xfd
    v_mfma_f32_16x16x32_bf16 v[40:43], v[140:143], v[108:111], v[40:43]
    s_waitcnt vmcnt(3)
    v_xor_b32 v112, s24, v80
    v_xor_b32 v113, s38, v81
    v_xor_b32 v114, s26, v82
    v_xor_b32 v115, s39, v83
    v_bitop3_b32 v52, v112, v114, v113 bitop3:0xfd
    v_bitop3_b32 v52, v52, v52, v115 bitop3:0xfd
    v_mfma_f32_16x16x32_bf16 v[40:43], v[144:147], v[112:115], v[40:43]
    v_or3_b32 v7, v7, v51, v52
    s_waitcnt vmcnt(2)
    v_xor_b32 v116, s24, v84
    v_xor_b32 v117, s38, v85
    v_xor_b32 v118, s26, v86
    v_xor_b32 v119, s39, v87
    v_bitop3_b32 v53, v116, v118, v117 bitop3:0xfd
    v_bitop3_b32 v53, v53, v53, v119 bitop3:0xfd
    v_mfma_f32_16x16x32_bf16 v[40:43], v[148:151], v[116:119], v[40:43]
    s_waitcnt vmcnt(1)
    v_xor_b32 v120, s24, v88
    v_xor_b32 v121, s38, v89
    v_xor_b32 v122, s26, v90
    v_xor_b32 v123, s39, v91
    v_bitop3_b32 v54, v120, v122, v121 bitop3:0xfd
    v_bitop3_b32 v54, v54, v54, v123 bitop3:0xfd
    v_mfma_f32_16x16x32_bf16 v[40:43], v[152:155], v[120:123], v[40:43]
    v_or3_b32 v7, v7, v53, v54
    s_waitcnt vmcnt(0)
    v_xor_b32 v124, s24, v92
    v_xor_b32 v125, s38, v93
    v_xor_b32 v126, s26, v94
    v_xor_b32 v127, s39, v95
    v_bitop3_b32 v55, v124, v126, v125 bitop3:0xfd
    v_bitop3_b32 v55, v55, v55, v127 bitop3:0xfd
    v_mfma_f32_16x16x32_bf16 v[40:43], v[156:159], v[124:127], v[40:43]
    v_or_b32 v7, v7, v55
    v_and_b32 v7, v30, v7
    v_cmp_ne_u32 vcc, 0, v7
    s_cbranch_vccz L_bok
L_bre:
    v_and_b32 v7, v30, v48
    v_cmp_ne_u32 vcc, 0, v7
    s_cbranch_vccz L_br0
    buffer_load_dwordx4 v[64:67], v11, s[56:59], s13 offen offset:0 sc1
L_br0:
    v_and_b32 v7, v30, v49
    v_cmp_ne_u32 vcc, 0, v7
    s_cbranch_vccz L_br1
    buffer_load_dwordx4 v[68:71], v11, s[56:59], s13 offen offset:1024 sc1
L_br1:
    v_and_b32 v7, v30, v50
    v_cmp_ne_u32 vcc, 0, v7
    s_cbranch_vccz L_br2
    buffer_load_dwordx4 v[72:75], v11, s[56:59], s13 offen offset:2048 sc1
L_br2:
    v_and_b32 v7, v30, v51
    v_cmp_ne_u32 vcc, 0, v7
    s_cbranch_vccz L_br3
    buffer_load_dwordx4 v[76:79], v11, s[56:59], s13 offen offset:3072 sc1
L_br3:
    v_and_b32 v7, v30, v52
    v_cmp_ne_u32 vcc, 0, v7
    s_cbranch_vccz L_br4
    buffer_load_dwordx4 v[80:83], v11, s[56:59], s14 offen offset:0 sc1
L_br4:
    v_and_b32 v7, v30, v53
    v_cmp_ne_u32 vcc, 0, v7
    s_cbranch_vccz L_br5
    buffer_load_dwordx4 v[84:87], v11, s[56:59], s14 offen offset:1024 sc1
L_br5:
    v_and_b32 v7, v30, v54
    v_cmp_ne_u32 vcc, 0, v7
    s_cbranch_vccz L_br6
    buffer_load_dwordx4 v[88:91], v11, s[56:59], s14 offen offset:2048 sc1
L_br6:
    v_and_b32 v7, v30, v55
    v_cmp_ne_u32 vcc, 0, v7
    s_cbranch_vccz L_br7
    buffer_load_dwordx4 v[92:95], v11, s[56:59], s14 offen offset:3072 sc1
L_br7:
    s_waitcnt vmcnt(0)
    v_xor_b32 v96, s24, v64
    v_xor_b32 v97, s38, v65
    v_xor_b32 v98, s26, v66
    v_xor_b32 v99, s39, v67
    v_bitop3_b32 v48, v96, v98, v97 bitop3:0xfd
    v_bitop3_b32 v48, v48, v48, v99 bitop3:0xfd
    v_mfma_f32_16x16x32_bf16 v[40:43], v[128:131], v[96:99], 0
    v_xor_b32 v100, s24, v68
    v_xor_b32 v101, s38, v69
    v_xor_b32 v102, s26, v70
    v_xor_b32 v103, s39, v71
    v_bitop3_b32 v49, v100, v102, v101 bitop3:0xfd
    v_bitop3_b32 v49, v49, v49, v103 bitop3:0xfd
    v_mfma_f32_16x16x32_bf16 v[40:43], v[132:135], v[100:103], v[40:43]
    v_xor_b32 v104, s24, v72
    v_xor_b32 v105, s38, v73
    v_xor_b32 v106, s26, v74
    v_xor_b32 v107, s39, v75
    v_bitop3_b32 v50, v104, v106, v105 bitop3:0xfd
    v_bitop3_b32 v50, v50, v50, v107 bitop3:0xfd
    v_mfma_f32_16x16x32_bf16 v[40:43], v[136:139], v[104:107], v[40:43]
    v_or3_b32 v7, v48, v49, v50
    v_xor_b32 v108, s24, v76
    v_xor_b32 v109, s38, v77
    v_xor_b32 v110, s26, v78
    v_xor_b32 v111, s39, v79
    v_bitop3_b32 v51, v108, v110, v109 bitop3:0xfd
    v_bitop3_b32 v51, v51, v51, v111 bitop3:0xfd
    v_mfma_f32_16x16x32_bf16 v[40:43], v[140:143], v[108:111], v[40:43]
    v_xor_b32 v112, s24, v80
    v_xor_b32 v113, s38, v81
    v_xor_b32 v114, s26, v82
    v_xor_b32 v115, s39, v83
    v_bitop3_b32 v52, v112, v114, v113 bitop3:0xfd
    v_bitop3_b32 v52, v52, v52, v115 bitop3:0xfd
    v_mfma_f32_16x16x32_bf16 v[40:43], v[144:147], v[112:115], v[40:43]
    v_or3_b32 v7, v7, v51, v52
    v_xor_b32 v116, s24, v84
    v_xor_b32 v117, s38, v85
    v_xor_b32 v118, s26, v86
    v_xor_b32 v119, s39, v87
    v_bitop3_b32 v53, v116, v118, v117 bitop3:0xfd
    v_bitop3_b32 v53, v53, v53, v119 bitop3:0xfd
    v_mfma_f32_16x16x32_bf16 v[40:43], v[148:151], v[116:119], v[40:43]
    v_xor_b32 v120, s24, v88
    v_xor_b32 v121, s38, v89
    v_xor_b32 v122, s26, v90
    v_xor_b32 v123, s39, v91
    v_bitop3_b32 v54, v120, v122, v121 bitop3:0xfd
    v_bitop3_b32 v54, v54, v54, v123 bitop3:0xfd
    v_mfma_f32_16x16x32_bf16 v[40:43], v[152:155], v[120:123], v[40:43]
    v_or3_b32 v7, v7, v53, v54
    v_xor_b32 v124, s24, v92
    v_xor_b32 v125, s38, v93
    v_xor_b32 v126, s26, v94
    v_xor_b32 v127, s39, v95
    v_bitop3_b32 v55, v124, v126, v125 bitop3:0xfd
    v_bitop3_b32 v55, v55, v55, v127 bitop3:0xfd
    v_mfma_f32_16x16x32_bf16 v[40:43], v[156:159], v[124:127], v[40:43]
    v_or_b32 v7, v7, v55
    v_and_b32 v7, v30, v7
    v_cmp_ne_u32 vcc, 0, v7
    s_add_u32 s28, s28, 1
    s_cmp_gt_u32 s28, 131072
    s_cbranch_scc1 L_exit
    s_cbranch_vccnz L_bre
L_bok:
    s_nop 3
    v_cvt_pk_bf16_f32 v44, v40, v41
    v_cvt_pk_bf16_f32 v45, v42, v43
    s_mov_b32 exec_hi, 0
    ds_write_b64 v12, v[44:45]
    s_mov_b64 exec, -1
    s_waitcnt lgkmcnt(0)
    s_setprio 2
    s_barrier
    ds_read_b128 v[64:67], v13
    ds_read2st64_b64 v[80:83], v31 offset0:2 offset1:18
    ds_read2st64_b64 v[84:87], v31 offset0:34 offset1:50
    ds_read_b128 v[68:71], v13 offset:64
    ds_read_b128 v[72:75], v13 offset:128
    ds_read_b128 v[76:79], v13 offset:192
    s_waitcnt lgkmcnt(5)
    v_mfma_f32_16x16x32_bf16 v[40:43], v[64:67], v[160:163], 0
    s_waitcnt lgkmcnt(2)
    v_mfma_f32_16x16x32_bf16 v[40:43], v[68:71], v[164:167], v[40:43]
    v_max3_f32 v4, v80, v82, v84
    v_max_f32 v4, v4, v86
    s_waitcnt lgkmcnt(1)
    v_mfma_f32_16x16x32_bf16 v[40:43], v[72:75], v[168:171], v[40:43]
    v_sub_f32 v80, v80, v4
    v_sub_f32 v82, v82, v4
    s_waitcnt lgkmcnt(0)
    v_mfma_f32_16x16x32_bf16 v[40:43], v[76:79], v[172:175], v[40:43]
    v_sub_f32 v84, v84, v4
    v_sub_f32 v86, v86, v4
    v_mfma_f32_16x16x32_bf16 v[44:47], v[64:67], v[176:179], 0
    v_exp_f32 v80, v80
    v_mfma_f32_16x16x32_bf16 v[44:47], v[68:71], v[180:183], v[44:47]
    v_exp_f32 v82, v82
    v_mfma_f32_16x16x32_bf16 v[44:47], v[72:75], v[184:187], v[44:47]
    v_exp_f32 v84, v84
    v_mfma_f32_16x16x32_bf16 v[44:47], v[76:79], v[188:191], v[44:47]
    v_exp_f32 v86, v86
    v_mul_f32 v5, v80, v81
    v_fmac_f32 v5, v82, v83
    v_fmac_f32 v5, v84, v85
    v_fmac_f32 v5, v86, v87
    v_rcp_f32 v5, v5
    v_mul_f32 v6, v40, v80
    v_fmac_f32 v6, v41, v82
    v_fmac_f32 v6, v42, v84
    v_fmac_f32 v6, v43, v86
    v_mul_f32 v7, v44, v80
    v_fmac_f32 v7, v45, v82
    v_fmac_f32 v7, v46, v84
    v_fmac_f32 v7, v47, v86
    v_cndmask_b32 v6, v6, v7, s[18:19]
    v_mul_f32 v6, v6, v5
    v_cvt_pk_bf16_f32 v6, v6, v6
    ds_write_b16 v14, v6
    s_waitcnt lgkmcnt(0)
    s_barrier
    s_branch L_exit
L_WO:
    s_load_dwordx2 s[60:61], s[0:1], 40
    s_barrier
L_WO1:
    s_mov_b32 s46, 16777216
    s_mov_b32 s47, 0x20000
    s_lshl4_add_u32 s14, s4, s5
    s_lshl2_add_u32 s14, s14, s3
    s_sub_u32 s14, s14, 4
    s_lshl_b32 s14, s14, 15
    v_lshrrev_b32 v5, 1, v0
    v_and_b32 v6, 1, v0
    v_lshlrev_b32 v5, 10, v5
    v_lshl_add_u32 v5, v6, 7, v5
    v_mov_b32 v44, v5
    s_mov_b32 s30, s14
    s_cmp_lg_u32 s4, 0
    s_cbranch_scc1 L_nocpf
    s_add_u32 s31, s30, 28672
    v_lshlrev_b32 v44, 7, v0
    s_mov_b32 exec_hi, 0
    buffer_load_dword v110, v44, s[44:47], s31 offen
    s_mov_b64 exec, -1
    s_add_u32 s31, s30, 24576
    v_lshlrev_b32 v44, 7, v0
    s_mov_b32 exec_hi, 0
    buffer_load_dword v111, v44, s[44:47], s31 offen
    s_mov_b64 exec, -1
    s_waitcnt vmcnt(1)
    s_branch L_nocpf2
L_nocpf:
L_nocpf2:
    s_mov_b32 s62, 4194304
    s_mov_b32 s63, 0x20000
    s_sub_u32 s9, s3, 4
    s_lshl_b32 s10, s7, 17
    s_lshl_b32 s11, s9, 8
    s_add_u32 s10, s10, s11
    s_lshl_b32 s11, s9, 15
    v_lshlrev_b32 v4, 2, v3
    v_xor_b32 v4, v4, v2
    v_lshlrev_b32 v4, 4, v4
    v_lshl_add_u32 v4, v3, 10, v4
    v_xor_b32 v5, 32, v4
    s_mov_b32 m0, s11
    s_lshl_b32 s13, s8, 15
    s_add_u32 s10, s10, s13
    s_cmp_eq_u32 s8, 3
    s_cselect_b32 s36, -31, 1
    s_lshl_b32 s36, s36, 12
    s_cmp_eq_u32 s8, 2
    s_cselect_b32 s37, -31, 1
    s_lshl_b32 s37, s37, 12
    s_cmp_eq_u32 s8, 1
    s_cselect_b32 s38, -31, 1
    s_lshl_b32 s38, s38, 12
    v_bfe_u32 v6, v0, 2, 2
    v_bfe_u32 v7, v0, 4, 1
    v_bfe_u32 v16, v0, 1, 1
    v_lshl_or_b32 v7, v7, 1, v16
    v_lshl_or_b32 v7, v6, 2, v7
    v_lshlrev_b32 v7, 4, v7
    v_lshlrev_b32 v6, 8, v6
    v_lshl_add_u32 v6, v3, 11, v6
    v_and_b32 v16, 1, v0
    v_lshl_add_u32 v6, v16, 3, v6
    v_add_u32 v6, s11, v6
    v_xor_b32 v16, 0, v7
    v_add_u32 v8, v6, v16
    v_xor_b32 v16, 32, v7
    v_add_u32 v9, v6, v16
    v_xor_b32 v16, 64, v7
    v_add_u32 v10, v6, v16
    v_xor_b32 v16, 96, v7
    v_add_u32 v11, v6, v16
    v_xor_b32 v16, 128, v7
    v_add_u32 v12, v6, v16
    v_xor_b32 v16, 160, v7
    v_add_u32 v13, v6, v16
    v_xor_b32 v16, 192, v7
    v_add_u32 v14, v6, v16
    v_xor_b32 v16, 224, v7
    v_add_u32 v15, v6, v16
    v_lshrrev_b32 v16, 1, v3
    v_add_u32 v16, s8, v16
    v_and_b32 v17, 1, v3
    v_and_b32 v18, 1, v0
    v_lshl_or_b32 v17, v17, 1, v18
    v_lshlrev_b32 v17, 4, v17
    v_add_u32 v17, 133120, v17
    v_and_b32 v36, 3, v16
    v_lshl_add_u32 v36, v36, 6, v17
    v_xor_b32 v37, 0x80, v36
    v_mul_u32_u24 v38, 0xaaaa, v18
    v_add_u32 v38, 0x4444, v38
    v_lshlrev_b32 v17, 2, v0
    v_and_b32 v19, 1, v0
    v_cmp_eq_u32 vcc, 0, v19
    v_mov_b32 v19, 0xff
    s_nop 0
    v_cndmask_b32 v18, 0, v19, vcc
    v_and_b32 v19, 3, v0
    v_add_u32 v19, s20, v19
    s_lshl2_add_u32 s12, s7, s8
    s_lshl_b32 s12, s12, 11
    s_lshl_b32 s13, s9, 9
    s_add_u32 s12, s12, s13
    s_add_u32 s12, s12, 524288
    s_add_u32 s13, s13, 135168
    v_add_u32 v39, s13, v17
    v_mov_b32 v64, 0
    v_mov_b32 v65, 0
    v_mov_b32 v66, 0
    v_mov_b32 v67, 0
    v_mov_b32 v68, 0
    v_mov_b32 v69, 0
    v_mov_b32 v70, 0
    v_mov_b32 v71, 0
    v_mov_b32 v72, 0
    v_mov_b32 v73, 0
    v_mov_b32 v74, 0
    v_mov_b32 v75, 0
    v_mov_b32 v76, 0
    v_mov_b32 v77, 0
    v_mov_b32 v78, 0
    v_mov_b32 v79, 0
    v_mov_b32 v80, 0
    v_mov_b32 v81, 0
    v_mov_b32 v82, 0
    v_mov_b32 v83, 0
    v_mov_b32 v84, 0
    v_mov_b32 v85, 0
    v_mov_b32 v86, 0
    v_mov_b32 v87, 0
    v_mov_b32 v88, 0
    v_mov_b32 v89, 0
    v_mov_b32 v90, 0
    v_mov_b32 v91, 0
    v_mov_b32 v92, 0
    v_mov_b32 v93, 0
    v_mov_b32 v94, 0
    v_mov_b32 v95, 0
    v_mov_b32 v96, 0
    v_mov_b32 v97, 0
    v_mov_b32 v98, 0
    v_mov_b32 v99, 0
    v_mov_b32 v100, 0
    v_mov_b32 v101, 0
    v_mov_b32 v102, 0
    v_mov_b32 v103, 0
    s_waitcnt lgkmcnt(0)
    s_barrier
    buffer_load_dwordx4 v4, s[60:63], s10 offen  lds
    s_add_u32 m0, m0, 1024
    s_add_u32 s10, s10, 4096
    buffer_load_dwordx4 v4, s[60:63], s10 offen  lds
    s_add_u32 m0, m0, 1024
    s_add_u32 s10, s10, 4096
    buffer_load_dwordx4 v5, s[60:63], s10 offen  lds
    s_add_u32 m0, m0, 1024
    s_add_u32 s10, s10, 4096
    buffer_load_dwordx4 v5, s[60:63], s10 offen  lds
    s_add_u32 m0, m0, 1024
    s_add_u32 s10, s10, 4096
    buffer_load_dwordx4 v4, s[60:63], s10 offen  lds
    s_add_u32 m0, m0, 1024
    s_add_u32 s10, s10, 4096
    buffer_load_dwordx4 v4, s[60:63], s10 offen  lds
    s_add_u32 m0, m0, 1024
    s_add_u32 s10, s10, 4096
    buffer_load_dwordx4 v5, s[60:63], s10 offen  lds
    s_add_u32 m0, m0, 1024
    s_add_u32 s10, s10, 4096
    buffer_load_dwordx4 v5, s[60:63], s10 offen  lds
    s_barrier
    s_add_u32 m0, m0, 1024
    s_add_u32 s10, s10, s36
    s_waitcnt vmcnt(7)
    buffer_load_dwordx4 v4, s[60:63], s10 offen  lds
    s_add_u32 m0, m0, 1024
    s_add_u32 s10, s10, 4096
    s_waitcnt vmcnt(7)
    buffer_load_dwordx4 v4, s[60:63], s10 offen  lds
    s_add_u32 m0, m0, 1024
    s_add_u32 s10, s10, 4096
    s_waitcnt vmcnt(7)
    buffer_load_dwordx4 v5, s[60:63], s10 offen  lds
    s_add_u32 m0, m0, 1024
    s_add_u32 s10, s10, 4096
    s_waitcnt vmcnt(7)
    buffer_load_dwordx4 v5, s[60:63], s10 offen  lds
    s_add_u32 m0, m0, 1024
    s_add_u32 s10, s10, 4096
    s_waitcnt vmcnt(7)
    buffer_load_dwordx4 v4, s[60:63], s10 offen  lds
    s_add_u32 m0, m0, 1024
    s_add_u32 s10, s10, 4096
    s_waitcnt vmcnt(7)
    buffer_load_dwordx4 v4, s[60:63], s10 offen  lds
    s_add_u32 m0, m0, 1024
    s_add_u32 s10, s10, 4096
    s_waitcnt vmcnt(7)
    buffer_load_dwordx4 v5, s[60:63], s10 offen  lds
    s_add_u32 m0, m0, 1024
    s_add_u32 s10, s10, 4096
    s_waitcnt vmcnt(7)
    ds_read_b64_tr_b16 v[128:129], v8 offset:0
    ds_read_b64_tr_b16 v[130:131], v8 offset:1024
    ds_read_b64_tr_b16 v[144:145], v9 offset:0
    ds_read_b64_tr_b16 v[146:147], v9 offset:1024
    ds_read_b64_tr_b16 v[160:161], v10 offset:0
    ds_read_b64_tr_b16 v[162:163], v10 offset:1024
    ds_read_b64_tr_b16 v[176:177], v11 offset:0
    ds_read_b64_tr_b16 v[178:179], v11 offset:1024
    ds_read_b64_tr_b16 v[192:193], v12 offset:0
    ds_read_b64_tr_b16 v[194:195], v12 offset:1024
    ds_read_b64_tr_b16 v[208:209], v13 offset:0
    ds_read_b64_tr_b16 v[210:211], v13 offset:1024
    ds_read_b64_tr_b16 v[224:225], v14 offset:0
    ds_read_b64_tr_b16 v[226:227], v14 offset:1024
    ds_read_b64_tr_b16 v[240:241], v15 offset:0
    ds_read_b64_tr_b16 v[242:243], v15 offset:1024
    buffer_load_dwordx4 v5, s[60:63], s10 offen  lds
    s_add_u32 m0, m0, 1024
    s_add_u32 s10, s10, s37
    s_waitcnt vmcnt(7)
    buffer_load_dwordx4 v4, s[60:63], s10 offen  lds
    s_add_u32 m0, m0, 1024
    s_add_u32 s10, s10, 4096
    s_waitcnt vmcnt(7)
    buffer_load_dwordx4 v4, s[60:63], s10 offen  lds
    s_barrier
    s_add_u32 m0, m0, 1024
    s_add_u32 s10, s10, 4096
    s_waitcnt vmcnt(7)
    buffer_load_dwordx4 v5, s[60:63], s10 offen  lds
    s_add_u32 m0, m0, 1024
    s_add_u32 s10, s10, 4096
    s_waitcnt vmcnt(7)
    buffer_load_dwordx4 v5, s[60:63], s10 offen  lds
    s_add_u32 m0, m0, 1024
    s_add_u32 s10, s10, 4096
    s_waitcnt vmcnt(7)
    buffer_load_dwordx4 v4, s[60:63], s10 offen  lds
    s_add_u32 m0, m0, 1024
    s_add_u32 s10, s10, 4096
    s_waitcnt vmcnt(7)
    buffer_load_dwordx4 v4, s[60:63], s10 offen  lds
    s_add_u32 m0, m0, 1024
    s_add_u32 s10, s10, 4096
    s_waitcnt vmcnt(7)
    buffer_load_dwordx4 v5, s[60:63], s10 offen  lds
    s_barrier
    s_add_u32 m0, m0, 1024
    s_add_u32 s10, s10, 4096
    s_waitcnt vmcnt(7)
    ds_read_b64_tr_b16 v[132:133], v8 offset:8192
    ds_read_b64_tr_b16 v[134:135], v8 offset:9216
    ds_read_b64_tr_b16 v[148:149], v9 offset:8192
    ds_read_b64_tr_b16 v[150:151], v9 offset:9216
    ds_read_b64_tr_b16 v[164:165], v10 offset:8192
    ds_read_b64_tr_b16 v[166:167], v10 offset:9216
    ds_read_b64_tr_b16 v[180:181], v11 offset:8192
    ds_read_b64_tr_b16 v[182:183], v11 offset:9216
    ds_read_b64_tr_b16 v[196:197], v12 offset:8192
    ds_read_b64_tr_b16 v[198:199], v12 offset:9216
    ds_read_b64_tr_b16 v[212:213], v13 offset:8192
    ds_read_b64_tr_b16 v[214:215], v13 offset:9216
    ds_read_b64_tr_b16 v[228:229], v14 offset:8192
    ds_read_b64_tr_b16 v[230:231], v14 offset:9216
    ds_read_b64_tr_b16 v[244:245], v15 offset:8192
    ds_read_b64_tr_b16 v[246:247], v15 offset:9216
    buffer_load_dwordx4 v5, s[60:63], s10 offen  lds
    s_add_u32 m0, m0, 1024
    s_add_u32 s10, s10, s38
    s_waitcnt vmcnt(7)
    buffer_load_dwordx4 v4, s[60:63], s10 offen  lds
    s_add_u32 m0, m0, 1024
    s_add_u32 s10, s10, 4096
    s_waitcnt vmcnt(7)
    buffer_load_dwordx4 v4, s[60:63], s10 offen  lds
    s_add_u32 m0, m0, 1024
    s_add_u32 s10, s10, 4096
    s_waitcnt vmcnt(7)
    buffer_load_dwordx4 v5, s[60:63], s10 offen  lds
    s_add_u32 m0, m0, 1024
    s_add_u32 s10, s10, 4096
    s_waitcnt vmcnt(7)
    buffer_load_dwordx4 v5, s[60:63], s10 offen  lds
    s_add_u32 m0, m0, 1024
    s_add_u32 s10, s10, 4096
    s_waitcnt vmcnt(7)
    buffer_load_dwordx4 v4, s[60:63], s10 offen  lds
    s_add_u32 m0, m0, 1024
    s_add_u32 s10, s10, 4096
    s_waitcnt vmcnt(7)
    buffer_load_dwordx4 v4, s[60:63], s10 offen  lds
    s_add_u32 m0, m0, 1024
    s_add_u32 s10, s10, 4096
    s_waitcnt vmcnt(7)
    buffer_load_dwordx4 v5, s[60:63], s10 offen  lds
    s_add_u32 m0, m0, 1024
    s_add_u32 s10, s10, 4096
    s_waitcnt vmcnt(7)
    ds_read_b64_tr_b16 v[136:137], v8 offset:16384
    ds_read_b64_tr_b16 v[138:139], v8 offset:17408
    ds_read_b64_tr_b16 v[152:153], v9 offset:16384
    ds_read_b64_tr_b16 v[154:155], v9 offset:17408
    ds_read_b64_tr_b16 v[168:169], v10 offset:16384
    ds_read_b64_tr_b16 v[170:171], v10 offset:17408
    ds_read_b64_tr_b16 v[184:185], v11 offset:16384
    ds_read_b64_tr_b16 v[186:187], v11 offset:17408
    ds_read_b64_tr_b16 v[200:201], v12 offset:16384
    ds_read_b64_tr_b16 v[202:203], v12 offset:17408
    ds_read_b64_tr_b16 v[216:217], v13 offset:16384
    ds_read_b64_tr_b16 v[218:219], v13 offset:17408
    ds_read_b64_tr_b16 v[232:233], v14 offset:16384
    ds_read_b64_tr_b16 v[234:235], v14 offset:17408
    ds_read_b64_tr_b16 v[248:249], v15 offset:16384
    ds_read_b64_tr_b16 v[250:251], v15 offset:17408
    buffer_load_dwordx4 v5, s[60:63], s10 offen  lds
    s_mov_b32 s40, 196611
    s_mov_b32 s41, 196611
    s_mov_b32 s42, 3145776
    s_mov_b32 s43, 3145776
    s_mov_b32 s44, 50332416
    s_mov_b32 s45, 50332416
    s_mov_b32 s46, 805318656
    s_mov_b32 s47, 805318656
    s_barrier
    ds_read_b32 v96, v39
    ds_read_b32 v100, v39 offset:256
    s_waitcnt vmcnt(0)
    ds_read_b64_tr_b16 v[140:141], v8 offset:24576
    ds_read_b64_tr_b16 v[142:143], v8 offset:25600
    ds_read_b64_tr_b16 v[156:157], v9 offset:24576
    ds_read_b64_tr_b16 v[158:159], v9 offset:25600
    ds_read_b64_tr_b16 v[172:173], v10 offset:24576
    ds_read_b64_tr_b16 v[174:175], v10 offset:25600
    ds_read_b64_tr_b16 v[188:189], v11 offset:24576
    ds_read_b64_tr_b16 v[190:191], v11 offset:25600
    ds_read_b64_tr_b16 v[204:205], v12 offset:24576
    ds_read_b64_tr_b16 v[206:207], v12 offset:25600
    ds_read_b64_tr_b16 v[220:221], v13 offset:24576
    ds_read_b64_tr_b16 v[222:223], v13 offset:25600
    ds_read_b64_tr_b16 v[236:237], v14 offset:24576
    ds_read_b64_tr_b16 v[238:239], v14 offset:25600
    ds_read_b64_tr_b16 v[252:253], v15 offset:24576
    ds_read_b64_tr_b16 v[254:255], v15 offset:25600
    s_mov_b64 exec, s[40:41]
    s_barrier
    ds_read_b128 v[64:67], v36
    ds_read_b128 v[68:71], v37
    s_mov_b64 exec, s[42:43]
    ds_read_b128 v[72:75], v36
    ds_read_b128 v[76:79], v37
    s_mov_b64 exec, s[44:45]
    ds_read_b128 v[80:83], v36
    ds_read_b128 v[84:87], v37
    s_mov_b64 exec, s[46:47]
    ds_read_b128 v[88:91], v36
    ds_read_b128 v[92:95], v37
    s_mov_b64 exec, -1
    s_waitcnt lgkmcnt(7)
    v_smfmac_f32_16x16x64_bf16 v[96:99], v[64:67], v[128:135], v38
    v_smfmac_f32_16x16x64_bf16 v[100:103], v[64:67], v[192:199], v38
    s_waitcnt lgkmcnt(6)
    v_smfmac_f32_16x16x64_bf16 v[96:99], v[68:71], v[136:143], v38
    v_smfmac_f32_16x16x64_bf16 v[100:103], v[68:71], v[200:207], v38
    s_waitcnt lgkmcnt(5)
    v_smfmac_f32_16x16x64_bf16 v[96:99], v[72:75], v[144:151], v38
    v_smfmac_f32_16x16x64_bf16 v[100:103], v[72:75], v[208:215], v38
    s_waitcnt lgkmcnt(4)
    v_smfmac_f32_16x16x64_bf16 v[96:99], v[76:79], v[152:159], v38
    v_smfmac_f32_16x16x64_bf16 v[100:103], v[76:79], v[216:223], v38
    s_waitcnt lgkmcnt(3)
    v_smfmac_f32_16x16x64_bf16 v[96:99], v[80:83], v[160:167], v38
    s_waitcnt lgkmcnt(2)
    v_smfmac_f32_16x16x64_bf16 v[96:99], v[84:87], v[168:175], v38
    s_waitcnt lgkmcnt(1)
    v_smfmac_f32_16x16x64_bf16 v[96:99], v[88:91], v[176:183], v38
    s_waitcnt lgkmcnt(0)
    v_smfmac_f32_16x16x64_bf16 v[96:99], v[92:95], v[184:191], v38
    v_smfmac_f32_16x16x64_bf16 v[100:103], v[80:83], v[224:231], v38
    v_smfmac_f32_16x16x64_bf16 v[100:103], v[84:87], v[232:239], v38
    v_smfmac_f32_16x16x64_bf16 v[100:103], v[88:91], v[240:247], v38
    v_smfmac_f32_16x16x64_bf16 v[100:103], v[92:95], v[248:255], v38
    s_nop 3
    v_add_f32 v96, v96, v97
    v_bfi_b32 v96, v18, v19, v96
    buffer_store_dword v96, v17, s[56:59], s12 offen sc1
    s_nop 0
    v_add_f32 v100, v100, v101
    v_bfi_b32 v100, v18, v19, v100
    buffer_store_dword v100, v17, s[56:59], s12 offen offset:256 sc1
L_exit:
L_end:
    s_endpgm
L_codeend:

.section .rodata,"a"
.p2align 6
.amdhsa_kernel parallel_sum__compressed_kv_cla__dense_activation_squared_relu__decode_kernel
  .amdhsa_next_free_vgpr 256
  .amdhsa_next_free_sgpr 102
  .amdhsa_accum_offset 256
  .amdhsa_group_segment_fixed_size 0
  .amdhsa_kernarg_size 112
  .amdhsa_user_sgpr_count 2
  .amdhsa_user_sgpr_kernarg_segment_ptr 1
  .amdhsa_system_sgpr_workgroup_id_x 1
  .amdhsa_float_denorm_mode_32 3
.end_amdhsa_kernel
```
